```python
import torch

def _softmax(x, axis=-1):
    return torch.softmax(x, dim=axis)
def _gelu(x):
    return torch.nn.functional.gelu(x, approximate="tanh")
def _silu(x):
    return torch.nn.functional.silu(x)
def _sigmoid(x):
    return torch.sigmoid(x)
def _layernorm(x, axis=-1, eps=1e-5):
    m = x.mean(dim=axis, keepdim=True)
    v = x.var(dim=axis, keepdim=True, unbiased=False)
    return (x - m) / torch.sqrt(v + eps)
def _scatter_add(tgt, idx, src, axis=0):
    return tgt.clone().index_add_(axis, idx, src)
def _segment_sum(src, seg, n):
    out = torch.zeros((n,) + src.shape[1:], dtype=src.dtype)
    return out.index_add_(0, seg, src)
def _pad(x, pw):
    flat = tuple(v for pair in reversed(pw) for v in pair)
    return torch.nn.functional.pad(x, flat)

kernel_name = 'recurrent_scan__compressed_kv_cla__glu_gated_geglu__decode'

def setup_inputs():

    _w = (lambda a: (lambda t: t.to(torch.bfloat16) if t.is_floating_point() else t)(torch.as_tensor(a)))
    def _A_setup():
        B, H, Sq, Sk, D, M = 4, 32, 1, 4096, 128, 576
        Dc = 4 * D
        return {
            "x": _w((lambda *s: torch.randn(*s, dtype=torch.bfloat16) * 0.05)(B, Sq, M)),
            "c_kv": _w((lambda *s: torch.randn(*s, dtype=torch.bfloat16) * 1.6)(B, Sk, Dc)),
            "w_q": _w((lambda *s: torch.randn(*s, dtype=torch.bfloat16) * 1.6)(M, H, D) * (M ** -0.5)),
            "w_uk": _w((lambda *s: torch.randn(*s, dtype=torch.bfloat16) * 1.6)(Dc, H, D) * (Dc ** -0.5)),
            "w_uv": _w((lambda *s: torch.randn(*s, dtype=torch.bfloat16) * 1.6)(Dc, H, D) * (Dc ** -0.5)),
            "w_o": _w((lambda *s: torch.randn(*s, dtype=torch.bfloat16) * 1.6)(H, D, M) * ((H * D) ** -0.5)),
        }
    _A_in = _A_setup()

    def _B_setup():
        B, S, Dm, Df = 4, 1, 576, 4608
        return {
            "x": _w((lambda *s: torch.randn(*s, dtype=torch.bfloat16) * 0.05)(B, S, Dm)),
            "w_gate": _w((lambda *s: torch.randn(*s, dtype=torch.bfloat16) * 0.2)(Dm, Df) * (Dm ** -0.5)),
            "w_up": _w((lambda *s: torch.randn(*s, dtype=torch.bfloat16) * 0.2)(Dm, Df) * (Dm ** -0.5)),
            "w_down": _w((lambda *s: torch.randn(*s, dtype=torch.bfloat16) * 0.2)(Df, Dm) * (Df ** -0.5)),
        }
    _B_in = _B_setup()

    return {
        "A_x": _A_in["x"],
        "A_c_kv": _A_in["c_kv"],
        "A_w_q": _A_in["w_q"],
        "A_w_uk": _A_in["w_uk"],
        "A_w_uv": _A_in["w_uv"],
        "A_w_o": _A_in["w_o"],
        "B_x": _B_in["x"],
        "B_w_gate": _B_in["w_gate"],
        "B_w_up": _B_in["w_up"],
        "B_w_down": _B_in["w_down"],
    }

def reference(A_x, A_c_kv, A_w_q, A_w_uk, A_w_uv, A_w_o, B_x, B_w_gate, B_w_up, B_w_down):
    def _A_ref(x, c_kv, w_q, w_uk, w_uv, w_o):
        B, Sq, M = x.shape[0], x.shape[1], x.shape[2]
        Sk = c_kv.shape[1]
        H, D = w_q.shape[1], w_q.shape[2]
        q = torch.einsum("bqm,mhd->bhqd", x, w_q)
        k = torch.einsum("bkc,chd->bhkd", c_kv, w_uk)
        v = torch.einsum("bkc,chd->bhkd", c_kv, w_uv)
        scores = torch.einsum("bhqd,bhkd->bhqk", q, k) * (D ** -0.5)
        off = Sk - Sq
        qi = torch.arange(Sq)[:, None]
        kj = torch.arange(Sk)[None, :]
        cmask = kj <= (qi + off)
        scores = torch.where(cmask[None, None], scores, -1e9)
        p = _softmax(scores, axis=-1)
        ctx = torch.einsum("bhqk,bhkd->bhqd", p, v)
        return torch.einsum("bhqd,hdm->bqm", ctx, w_o)

    def _B_ref(x, w_gate, w_up, w_down):
        g = torch.einsum("bsd,df->bsf", x, w_gate)
        u = torch.einsum("bsd,df->bsf", x, w_up)
        h = _gelu(g) * u
        return torch.einsum("bsf,fd->bsd", h, w_down)

    x = A_x
    xn = _layernorm(x, axis=-1)
    s = _A_ref(xn, A_c_kv, A_w_q, A_w_uk, A_w_uv, A_w_o)
    g = _silu(_B_ref(xn, B_w_gate, B_w_up, B_w_down))
    return x + s * g
```

```asm
; @launch grid=(256,1,1) block=(576,1,1) lds=163840
.amdgcn_target "amdgcn-amd-amdhsa--gfx950"
.text
.globl recurrent_scan__compressed_kv_cla__glu_gated_geglu__decode_kernel
.p2align 8
.type recurrent_scan__compressed_kv_cla__glu_gated_geglu__decode_kernel,@function
recurrent_scan__compressed_kv_cla__glu_gated_geglu__decode_kernel:
    s_cmp_ge_u32 s2, 256
    s_cbranch_scc1 L_end
    s_load_dwordx8 s[24:31], s[0:1], 0
    s_load_dwordx2 s[48:49], s[0:1], 96
    v_and_b32 v1, 63, v0
    v_lshrrev_b32 v4, 6, v0
    v_lshrrev_b32 v2, 4, v1
    v_and_b32 v3, 15, v1
    v_readfirstlane_b32 s3, v4
    s_and_b32 s4, s2, 7
    s_lshr_b32 s5, s2, 3
    s_cmp_lg_u32 s3, 0
    s_nop 0
    s_cbranch_scc1 L_nowarm
    s_getpc_b64 s[52:53]
L_pc:
    s_lshl_b32 s55, s5, 10
    v_lshlrev_b32 v4, 7, v1
    v_add_u32 v4, s55, v4
    v_min_u32 v4, L_codeend-L_pc-4, v4
    s_mov_b64 exec, 0xff
    global_load_dword v167, v4, s[52:53]
    s_mov_b64 exec, -1
L_nowarm:
    s_mov_b32 s10, 4608
    s_mov_b32 s11, 0x20000
    s_mov_b32 s14, 16777216
    s_mov_b32 s15, 0x20000
    s_mov_b32 s18, 4718592
    s_mov_b32 s19, 0x20000
    s_mov_b32 s22, 4194304
    s_mov_b32 s23, 0x20000
    s_mov_b32 s50, 268435456
    s_mov_b32 s51, 0x20000
    s_cmp_ge_u32 s5, 16
    s_cbranch_scc1 L_K
    s_lshr_b32 s57, s5, 2
    s_xor_b32 s57, s57, 2
    s_lshl_b32 s59, s4, 2
    s_add_u32 s57, s57, s59
    s_and_b32 s58, s5, 3
    v_lshrrev_b32 v4, 3, v3
    v_lshlrev_b32 v4, 2, v4
    v_add_u32 v4, v4, v2
    v_mul_u32_u24 v4, 32768, v4
    v_and_b32 v5, 7, v3
    v_lshl_add_u32 v5, v5, 4, v4
    s_lshr_b32 s59, s58, 1
    s_mul_i32 s59, s59, 2359296
    s_lshl_b32 s60, s3, 18
    s_add_u32 s59, s59, s60
    s_lshl_b32 s60, s57, 8
    s_add_u32 s59, s59, s60
    s_and_b32 s61, s58, 1
    s_lshl_b32 s61, s61, 7
    s_add_u32 s59, s59, s61
    v_lshlrev_b32 v6, 1, v1
    v_lshlrev_b32 v13, 4, v1
    s_mul_i32 s61, s3, 1152
    s_setprio 2
    v_mov_b32 v10, 0
    s_waitcnt lgkmcnt(0)
    s_mov_b64 s[8:9], s[24:25]
    s_mov_b64 s[16:17], s[28:29]
    s_cmp_ge_u32 s3, 4
    s_cbranch_scc1 L_P_nox
    buffer_load_dwordx4 v[100:103], v13, s[8:11], s61 offen
    buffer_load_ushort v104, v6, s[8:11], s61 offen offset:1024
L_P_nox:
    s_cmp_lg_u32 s3, 8
    s_cbranch_scc1 L_P_noclr
    v_lshlrev_b32 v4, 7, v1
    s_lshl_b32 s60, s57, 2
    s_add_u32 s60, s60, s58
    s_lshl_b32 s60, s60, 11
    s_add_u32 s60, s60, 327680
    s_mov_b64 exec, 0xffff
    buffer_load_dword v96, v4, s[48:51], s60 offen
    s_mov_b64 exec, -1
L_P_noclr:
    buffer_load_dwordx4 v[16:19], v5, s[16:19], s59 offen nt
    s_add_u32 s59, s59, 8192
    buffer_load_dwordx4 v[20:23], v5, s[16:19], s59 offen nt
    s_add_u32 s59, s59, 8192
    buffer_load_dwordx4 v[24:27], v5, s[16:19], s59 offen nt
    s_add_u32 s59, s59, 8192
    buffer_load_dwordx4 v[28:31], v5, s[16:19], s59 offen nt
    s_branch L_P_rest
L_K:
    s_sub_u32 s57, s5, 16
    s_lshl_b32 s58, s4, 4
    s_add_u32 s58, s58, s57
    v_lshlrev_b32 v5, 4, v1
    s_lshl_b32 s68, s58, 17
    s_lshl_b32 s67, s3, 10
    s_add_u32 s68, s68, s67
    s_lshl_b32 s60, s3, 14
    s_and_b32 s59, s3, 1
    s_lshl_b32 s59, s59, 4
    s_and_b32 s61, s3, 6
    s_lshl_b32 s61, s61, 5
    s_or_b32 s59, s59, s61
    v_xor_b32 v10, s59, v5
    v_xor_b32 v11, 32, v10
    s_waitcnt lgkmcnt(0)
    s_mov_b64 s[12:13], s[26:27]
    s_mov_b64 s[16:17], s[28:29]
    s_mov_b64 s[20:21], s[30:31]
    s_mov_b64 s[8:9], s[24:25]
    s_cmp_eq_u32 s4, 7
    s_cselect_b32 s61, 4, 2
    s_cmp_ge_u32 s3, s61
    s_cbranch_scc1 L_K_nt
    s_lshl_b32 s61, s4, 10
    v_lshlrev_b32 v4, 13, v1
    s_and_b32 s62, s3, 2
    s_lshl_b32 s62, s62, 8
    s_add_u32 s61, s61, s62
    s_bitcmp1_b32 s3, 0
    s_cbranch_scc1 L_K_tu
    s_mul_i32 s62, s57, 294912
    s_add_u32 s61, s61, s62
    s_mov_b32 exec_hi, 0xf
    buffer_load_dword v167, v4, s[16:19], s61 offen offset:384
    s_branch L_K_nt
L_K_tu:
    s_lshl_b32 s62, s57, 18
    s_add_u32 s61, s61, s62
    s_mov_b32 exec_hi, 0
    buffer_load_dword v167, v4, s[20:23], s61 offen offset:384
L_K_nt:
    s_mov_b64 exec, -1
    s_mov_b32 s56, 0
    s_cmp_eq_u32 s3, 8
    s_cbranch_scc1 L_K8
    s_add_u32 m0, s67, 0
    s_nop 0
    buffer_load_dwordx4 v10, s[12:15], s68 offen nt lds
    s_branch L_K_rest
L_P_rest:
    s_mov_b64 s[12:13], s[26:27]
    s_mov_b64 s[20:21], s[30:31]
    s_load_dwordx4 s[24:27], s[0:1], 32
    s_load_dwordx8 s[36:43], s[0:1], 56
    s_load_dword s54, s[48:49], 0
    s_mov_b32 s6, 0x05040100
    s_mov_b32 s7, 0x07060302
    s_lshl_b32 s63, s4, 4
    s_add_u32 s63, s63, s5
    s_lshl_b32 s66, s57, 11
    s_lshl_b32 s67, s58, 9
    s_add_u32 s66, s66, s67
    s_add_u32 s66, s66, 589824
    s_setprio 0
    v_lshlrev_b32 v12, 16, v2
    v_lshl_add_u32 v12, v3, 3, v12
    s_and_b32 s65, s3, 3
    s_lshl_b32 s67, s65, 7
    s_add_u32 s66, s66, s67
    s_lshr_b32 s69, s3, 2
    s_lshl_b32 s67, s58, 20
    s_lshl_b32 s68, s3, 17
    s_add_u32 s67, s67, s68
    s_lshl_b32 s68, s57, 8
    s_add_u32 s67, s67, s68
    s_and_b32 s68, s3, 1
    s_lshl_b32 s68, s68, 3
    v_lshrrev_b32 v4, 1, v2
    v_xor_b32 v4, v4, v3
    v_xor_b32 v4, s68, v4
    v_lshlrev_b32 v4, 4, v4
    v_lshl_add_u32 v11, v2, 13, v4
    s_barrier
    s_cmp_ge_u32 s3, 8
    s_cbranch_scc1 L_P_nob
    s_lshl_b32 s68, s3, 12
    s_add_u32 s68, s68, 32768
    s_add_u32 m0, s68, 0
    v_xor_b32 v4, 0, v11
    buffer_load_dwordx4 v4, s[20:23], s67 offen nt lds
    s_add_u32 s67, s67, 32768
    s_add_u32 m0, s68, 1024
    v_xor_b32 v4, 32, v11
    buffer_load_dwordx4 v4, s[20:23], s67 offen nt lds
    s_add_u32 s67, s67, 32768
    s_add_u32 m0, s68, 2048
    v_xor_b32 v4, 64, v11
    buffer_load_dwordx4 v4, s[20:23], s67 offen nt lds
    s_add_u32 s67, s67, 32768
    s_add_u32 m0, s68, 3072
    v_xor_b32 v4, 96, v11
    buffer_load_dwordx4 v4, s[20:23], s67 offen nt lds
    s_nop 0
L_P_nob:
    v_lshrrev_b32 v4, 2, v3
    v_and_b32 v4, 2, v4
    v_add_u32 v4, v4, v3
    v_and_b32 v4, 3, v4
    v_mul_u32_u24 v14, 1152, v4
    v_bfe_u32 v4, v3, 2, 1
    v_mul_u32_u24 v4, 32, v4
    v_add_u32 v14, v14, v4
    v_mul_u32_u24 v4, 8, v2
    v_add_u32 v14, v14, v4
    s_lshr_b32 s59, s58, 1
    s_mul_i32 s59, s59, 576
    s_lshl_b32 s60, s3, 6
    s_add_u32 s59, s59, s60
    v_add_u32 v14, s59, v14
    v_and_b32 v15, 7, v1
    v_lshlrev_b32 v15, 5, v15
    v_lshl_add_u32 v15, v2, 8, v15
    s_lshl_b32 s59, s3, 10
    s_add_u32 s59, s59, 8192
    v_add_u32 v15, s59, v15
    s_cmp_ge_u32 s3, 4
    s_cbranch_scc1 L_P_noln
    s_waitcnt vmcnt(8)
    v_lshlrev_b32 v96, 16, v100
    v_and_b32 v97, 0xffff0000, v100
    v_lshlrev_b32 v98, 16, v101
    v_and_b32 v99, 0xffff0000, v101
    v_lshlrev_b32 v100, 16, v102
    v_and_b32 v101, 0xffff0000, v102
    v_lshlrev_b32 v102, 16, v103
    v_and_b32 v103, 0xffff0000, v103
    v_lshlrev_b32 v104, 16, v104
    v_add_f32 v108, v96, v97
    v_add_f32 v108, v108, v98
    v_add_f32 v108, v108, v99
    v_add_f32 v108, v108, v100
    v_add_f32 v108, v108, v101
    v_add_f32 v108, v108, v102
    v_add_f32 v108, v108, v103
    v_add_f32 v108, v108, v104
    s_nop 1
    v_add_f32_dpp v108, v108, v108 row_ror:8 row_mask:0xf bank_mask:0xf
    s_nop 1
    v_add_f32_dpp v108, v108, v108 row_ror:4 row_mask:0xf bank_mask:0xf
    s_nop 1
    v_add_f32_dpp v108, v108, v108 row_ror:2 row_mask:0xf bank_mask:0xf
    s_nop 1
    v_add_f32_dpp v108, v108, v108 row_ror:1 row_mask:0xf bank_mask:0xf
    v_mov_b32 v109, v108
    s_nop 1
    v_permlane16_swap_b32 v108, v109
    v_add_f32 v108, v108, v109
    v_mov_b32 v109, v108
    s_nop 1
    v_permlane32_swap_b32 v108, v109
    v_add_f32 v108, v108, v109
    v_mul_f32 v108, 0x3ae38e39, v108
    v_sub_f32 v110, v96, v108
    v_mul_f32 v109, v110, v110
    v_sub_f32 v110, v97, v108
    v_fmac_f32 v109, v110, v110
    v_sub_f32 v110, v98, v108
    v_fmac_f32 v109, v110, v110
    v_sub_f32 v110, v99, v108
    v_fmac_f32 v109, v110, v110
    v_sub_f32 v110, v100, v108
    v_fmac_f32 v109, v110, v110
    v_sub_f32 v110, v101, v108
    v_fmac_f32 v109, v110, v110
    v_sub_f32 v110, v102, v108
    v_fmac_f32 v109, v110, v110
    v_sub_f32 v110, v103, v108
    v_fmac_f32 v109, v110, v110
    v_sub_f32 v110, v104, v108
    v_fmac_f32 v109, v110, v110
    v_cvt_pk_bf16_f32 v108, v108, v108
    v_and_b32 v108, 0xffff0000, v108
    v_add_f32_dpp v109, v109, v109 row_ror:8 row_mask:0xf bank_mask:0xf
    v_sub_f32 v96, v96, v108
    v_sub_f32 v97, v97, v108
    v_add_f32_dpp v109, v109, v109 row_ror:4 row_mask:0xf bank_mask:0xf
    v_sub_f32 v98, v98, v108
    v_sub_f32 v99, v99, v108
    v_add_f32_dpp v109, v109, v109 row_ror:2 row_mask:0xf bank_mask:0xf
    v_sub_f32 v100, v100, v108
    v_sub_f32 v101, v101, v108
    v_add_f32_dpp v109, v109, v109 row_ror:1 row_mask:0xf bank_mask:0xf
    v_sub_f32 v102, v102, v108
    v_sub_f32 v103, v103, v108
    v_sub_f32 v104, v104, v108
    v_mov_b32 v110, v109
    s_nop 1
    v_permlane16_swap_b32 v109, v110
    v_add_f32 v109, v109, v110
    v_mov_b32 v110, v109
    s_nop 1
    v_permlane32_swap_b32 v109, v110
    v_add_f32 v109, v109, v110
    v_mul_f32 v109, 0x3ae38e39, v109
    v_cvt_pk_bf16_f32 v109, v109, v109
    v_and_b32 v109, 0xffff0000, v109
    v_add_f32 v109, 0x3727c5ac, v109
    v_cvt_pk_bf16_f32 v109, v109, v109
    v_and_b32 v109, 0xffff0000, v109
    v_sqrt_f32 v109, v109
    s_nop 0
    v_cvt_pk_bf16_f32 v109, v109, v109
    v_and_b32 v109, 0xffff0000, v109
    v_rcp_f32 v109, v109
    v_cvt_pk_bf16_f32 v96, v96, v97
    v_and_b32 v97, 0xffff0000, v96
    v_lshlrev_b32 v96, 16, v96
    v_cvt_pk_bf16_f32 v98, v98, v99
    v_and_b32 v99, 0xffff0000, v98
    v_lshlrev_b32 v98, 16, v98
    v_cvt_pk_bf16_f32 v100, v100, v101
    v_and_b32 v101, 0xffff0000, v100
    v_lshlrev_b32 v100, 16, v100
    v_cvt_pk_bf16_f32 v102, v102, v103
    v_and_b32 v103, 0xffff0000, v102
    v_lshlrev_b32 v102, 16, v102
    v_cvt_pk_bf16_f32 v104, v104, v104
    v_lshlrev_b32 v104, 16, v104
    v_mul_f32 v96, v96, v109
    v_mul_f32 v97, v97, v109
    v_mul_f32 v98, v98, v109
    v_mul_f32 v99, v99, v109
    v_mul_f32 v100, v100, v109
    v_mul_f32 v101, v101, v109
    v_mul_f32 v102, v102, v109
    v_mul_f32 v103, v103, v109
    v_mul_f32 v104, v104, v109
    v_cvt_pk_bf16_f32 v96, v96, v97
    v_cvt_pk_bf16_f32 v97, v98, v99
    v_cvt_pk_bf16_f32 v98, v100, v101
    v_cvt_pk_bf16_f32 v99, v102, v103
    v_cvt_pk_bf16_f32 v104, v104, v104
    v_add_u32 v6, s61, v6
    v_add_u32 v13, s61, v13
    ds_write_b128 v13, v[96:99] offset:0
    ds_write_b16 v6, v104 offset:1024
L_P_noln:
    s_waitcnt lgkmcnt(0)
    s_mov_b64 s[28:29], s[26:27]
    s_mov_b64 s[32:33], s[36:37]
    s_mov_b64 s[36:37], s[38:39]
    s_mov_b64 s[44:45], s[42:43]
    s_mov_b32 s26, 4194304
    s_mov_b32 s27, 0x20000
    s_mov_b32 s30, 4718592
    s_mov_b32 s31, 0x20000
    s_mov_b32 s34, 5308416
    s_mov_b32 s35, 0x20000
    s_mov_b32 s38, 5308416
    s_mov_b32 s39, 0x20000
    s_mov_b32 s42, 5308416
    s_mov_b32 s43, 0x20000
    s_mov_b32 s46, 4608
    s_mov_b32 s47, 0x20000
    s_mul_i32 s54, s54, 1664525
    s_add_u32 s54, s54, 1013904223
    s_getreg_b32 s53, hwreg(HW_REG_XCC_ID, 0, 4)
    s_add_u32 s53, s53, s54
    s_add_u32 s53, s53, 1
    s_barrier
    ds_read_b64 v[164:165], v14 offset:0
    v_lshlrev_b32 v9, 2, v0
    s_lshl_b32 s59, s57, 13
    s_add_u32 s59, s59, 65536
    s_cmp_eq_u32 s3, 8
    s_cbranch_scc1 L_P_w0
    s_waitcnt vmcnt(4)
    s_branch L_P_w1
L_P_w0:
    s_waitcnt vmcnt(0)
L_P_w1:
    s_waitcnt lgkmcnt(0)
    v_perm_b32 v108, v20, v16, s6
    v_perm_b32 v109, v28, v24, s6
    v_perm_b32 v110, v20, v16, s7
    v_perm_b32 v111, v28, v24, s7
    v_mfma_f32_16x16x16_bf16 v[124:127], v[164:165], v[108:109], 0
    v_perm_b32 v112, v21, v17, s6
    v_perm_b32 v113, v29, v25, s6
    v_mfma_f32_16x16x16_bf16 v[128:131], v[164:165], v[110:111], 0
    v_perm_b32 v114, v21, v17, s7
    v_perm_b32 v115, v29, v25, s7
    v_mfma_f32_16x16x16_bf16 v[132:135], v[164:165], v[112:113], 0
    v_perm_b32 v116, v22, v18, s6
    v_perm_b32 v117, v30, v26, s6
    v_mfma_f32_16x16x16_bf16 v[136:139], v[164:165], v[114:115], 0
    v_perm_b32 v118, v22, v18, s7
    v_perm_b32 v119, v30, v26, s7
    v_mfma_f32_16x16x16_bf16 v[140:143], v[164:165], v[116:117], 0
    v_perm_b32 v120, v23, v19, s6
    v_perm_b32 v121, v31, v27, s6
    v_mfma_f32_16x16x16_bf16 v[144:147], v[164:165], v[118:119], 0
    v_perm_b32 v122, v23, v19, s7
    v_perm_b32 v123, v31, v27, s7
    v_mfma_f32_16x16x16_bf16 v[148:151], v[164:165], v[120:121], 0
    s_nop 0
    v_mfma_f32_16x16x16_bf16 v[152:155], v[164:165], v[122:123], 0
    v_permlane16_swap_b32 v124, v125
    v_permlane16_swap_b32 v128, v129
    v_permlane16_swap_b32 v132, v133
    v_permlane16_swap_b32 v136, v137
    v_permlane16_swap_b32 v140, v141
    v_permlane16_swap_b32 v144, v145
    v_permlane16_swap_b32 v148, v149
    s_nop 0
    v_permlane16_swap_b32 v152, v153
    v_add_f32_dpp v156, v125, v124 row_ror:8 row_mask:0xf bank_mask:0xf
    v_add_f32_dpp v157, v129, v128 row_ror:8 row_mask:0xf bank_mask:0xf
    v_add_f32_dpp v158, v133, v132 row_ror:8 row_mask:0xf bank_mask:0xf
    v_add_f32_dpp v159, v137, v136 row_ror:8 row_mask:0xf bank_mask:0xf
    v_add_f32_dpp v160, v141, v140 row_ror:8 row_mask:0xf bank_mask:0xf
    v_add_f32_dpp v161, v145, v144 row_ror:8 row_mask:0xf bank_mask:0xf
    v_add_f32_dpp v162, v149, v148 row_ror:8 row_mask:0xf bank_mask:0xf
    v_add_f32_dpp v163, v153, v152 row_ror:8 row_mask:0xf bank_mask:0xf
    s_mov_b32 exec_lo, 0x00ff00ff
    s_mov_b32 exec_hi, 0x00ff00ff
    ds_write_b128 v15, v[156:159] offset:0
    ds_write_b128 v15, v[160:163] offset:16
    s_mov_b64 exec, -1
    s_waitcnt lgkmcnt(0)
    s_barrier
    s_cmp_ge_u32 s3, 4
    s_cbranch_scc1 L_P_nored
    ds_read2st64_b32 v[108:109], v9 offset0:32 offset1:36
    ds_read2st64_b32 v[110:111], v9 offset0:40 offset1:44
    ds_read2st64_b32 v[112:113], v9 offset0:48 offset1:52
    ds_read2st64_b32 v[114:115], v9 offset0:56 offset1:60
    ds_read_b32 v116, v9 offset:16384
    s_lshl_b32 s60, s58, 11
    s_add_u32 s60, s60, s59
    v_lshlrev_b32 v4, 3, v0
    s_waitcnt lgkmcnt(0)
    v_add_f32 v108, v108, v109
    v_add_f32 v110, v110, v111
    v_add_f32 v112, v112, v113
    v_add_f32 v114, v114, v115
    v_add_f32 v108, v108, v110
    v_add_f32 v112, v112, v114
    v_add_f32 v108, v108, v112
    v_add_f32 v108, v108, v116
    v_mov_b32 v109, s53
    s_add_u32 s61, s60, 262144
    buffer_store_dwordx2 v[108:109], v4, s[48:51], s61 offen
    v_mov_b32 v10, v4
    s_nop 1
L_P_nored:
    s_cmp_lg_u32 s69, 1
    s_cbranch_scc1 L_P_nogather
    s_lshl_b32 s60, s65, 9
    s_add_u32 s60, s60, s59
    s_add_u32 s67, s60, 4096
    v_and_b32 v4, 31, v1
    v_lshlrev_b32 v4, 4, v4
    v_lshrrev_b32 v5, 5, v1
    v_lshl_add_u32 v4, v5, 11, v4
    s_lshl_b32 s68, s65, 8
    v_lshl_add_u32 v5, v1, 2, s68
    s_waitcnt vmcnt(0)
    s_mov_b32 s55, 0
L_P_ha:
    s_mov_b32 s61, 262144
    s_mov_b32 s52, s53
    s_cmp_lt_u32 s55, 24
    s_cbranch_scc1 L_P_hal
    s_bitcmp1_b32 s55, 0
    s_cbranch_scc1 L_P_hal
    v_lshlrev_b32 v6, 3, v1
    s_lshl_b32 s68, s58, 11
    s_add_u32 s68, s68, s60
    s_add_u32 s61, s61, s68
    buffer_load_dwordx2 v[112:113], v6, s[48:51], s61 offen sc1
    s_mov_b32 s61, 0
    s_mov_b32 s52, s54
    s_waitcnt vmcnt(0)
    v_cmp_ne_u32 vcc, s53, v113
    s_nop 0
    s_cbranch_vccnz L_P_hal
    v_mov_b32 v113, s54
    buffer_store_dwordx2 v[112:113], v6, s[48:51], s68 offen sc1
    s_nop 0
L_P_hal:
    s_add_u32 s68, s60, s61
    s_add_u32 s61, s67, s61
    buffer_load_dwordx4 v[112:115], v4, s[48:51], s68 offen sc1
    buffer_load_dwordx4 v[116:119], v4, s[48:51], s61 offen sc1
    s_waitcnt vmcnt(0)
    v_xor_b32 v113, s52, v113
    v_xor_b32 v115, s52, v115
    v_xor_b32 v117, s52, v117
    v_xor_b32 v119, s52, v119
    v_or3_b32 v113, v113, v115, v117
    v_or_b32 v113, v113, v119
    v_cmp_ne_u32 vcc, 0, v113
    s_nop 0
    s_cbranch_vccz L_sd_1
    s_add_u32 s55, s55, 1
    s_cmp_lt_u32 s55, 524288
    s_cbranch_scc1 L_P_ha
L_sd_1:
    v_add_f32 v112, v112, v116
    v_add_f32 v114, v114, v118
    v_cvt_pk_bf16_f32 v112, v112, v114
    ds_write_b32 v5, v112 offset:4608
    s_nop 0
L_P_nogather:
    v_lshrrev_b32 v4, 2, v3
    v_lshlrev_b32 v4, 8, v4
    v_lshl_add_u32 v4, v2, 4, v4
    v_xor_b32 v5, v2, v3
    v_lshlrev_b32 v5, 4, v5
    v_lshl_add_u32 v5, v3, 9, v5
    s_lshl_b32 s68, s65, 13
    s_add_u32 s68, s68, 32768
    v_add_u32 v5, s68, v5
    s_cmp_eq_u32 s3, 8
    s_cbranch_scc1 L_P_w8
    s_waitcnt vmcnt(1)
L_P_w8:
    s_waitcnt lgkmcnt(0)
    s_barrier
    s_cmp_lg_u32 s69, 1
    s_cbranch_scc1 L_P_nob2
    ds_read_b128 v[108:111], v4 offset:4608
    ds_read_b128 v[32:35], v5 offset:0
    ds_read_b128 v[36:39], v5 offset:256
    ds_read_b128 v[112:115], v4 offset:4672
    v_xor_b32 v6, 64, v5
    ds_read_b128 v[40:43], v6 offset:0
    ds_read_b128 v[44:47], v6 offset:256
    ds_read_b128 v[116:119], v4 offset:4736
    v_xor_b32 v6, 128, v5
    ds_read_b128 v[48:51], v6 offset:0
    ds_read_b128 v[52:55], v6 offset:256
    ds_read_b128 v[120:123], v4 offset:4800
    v_xor_b32 v6, 192, v5
    ds_read_b128 v[56:59], v6 offset:0
    ds_read_b128 v[60:63], v6 offset:256
    v_mov_b32 v157, s54
    s_waitcnt lgkmcnt(9)
    v_mfma_f32_16x16x32_bf16 v[124:127], v[108:111], v[32:35], 0
    v_mfma_f32_16x16x32_bf16 v[128:131], v[108:111], v[36:39], 0
    s_waitcnt lgkmcnt(6)
    v_mfma_f32_16x16x32_bf16 v[124:127], v[112:115], v[40:43], v[124:127]
    v_mfma_f32_16x16x32_bf16 v[128:131], v[112:115], v[44:47], v[128:131]
    s_waitcnt lgkmcnt(3)
    v_mfma_f32_16x16x32_bf16 v[124:127], v[116:119], v[48:51], v[124:127]
    v_mfma_f32_16x16x32_bf16 v[128:131], v[116:119], v[52:55], v[128:131]
    s_waitcnt lgkmcnt(0)
    v_mfma_f32_16x16x32_bf16 v[124:127], v[120:123], v[56:59], v[124:127]
    v_mfma_f32_16x16x32_bf16 v[128:131], v[120:123], v[60:63], v[128:131]
    s_nop 7
    v_cvt_pk_bf16_f32 v156, v124, v128
    buffer_store_dwordx2 v[156:157], v12, s[48:51], s66 offen sc1
    s_nop 0
L_P_nob2:
    s_barrier
    v_mov_b32 v164, v108
    v_mov_b32 v165, v109
    v_mov_b32 v166, v10
    s_mov_b32 s56, s60
    s_cmp_ge_u32 s3, 4
    s_cbranch_scc1 L_P_nc
    v_lshlrev_b32 v4, 7, v1
    s_lshl_b32 s59, s4, 4
    s_add_u32 s59, s59, s5
    s_lshl_b32 s59, s59, 17
    s_add_u32 s60, s3, 12
    s_lshl_b32 s60, s60, 13
    s_add_u32 s59, s59, s60
    buffer_load_dword v12, v4, s[12:15], s59 offen
L_P_nc:
    s_barrier
    s_lshl_b32 s62, s58, 1
    s_add_u32 s62, s62, s3
    s_sub_u32 s62, s62, 1
    s_cmp_eq_u32 s58, 0
    s_cselect_b32 s61, 1, 0
    s_sub_u32 s62, s62, s61
    s_add_u32 s69, s61, 4
    v_mul_u32_u24 v4, 239616, v2
    v_and_b32 v7, 3, v1
    v_lshl_add_u32 v7, v7, 4, v4
    v_and_b32 v4, 8, v1
    v_lshl_add_u32 v7, v4, 3, v7
    v_bfe_u32 v4, v1, 2, 1
    v_mul_u32_u24 v4, 13312, v4
    v_add_u32 v7, v7, v4
    s_mul_i32 s64, s62, 208
    s_add_u32 s64, s64, s57
    s_lshl_b32 s64, s64, 7
    s_add_u32 s64, s64, 1048576
    s_cmp_ge_u32 s3, 2
    s_cbranch_scc1 L_D_nod
    v_lshrrev_b32 v4, 1, v2
    v_mul_u32_u24 v4, 12, v4
    v_and_b32 v5, 1, v2
    v_lshl_add_u32 v4, v5, 1, v4
    v_lshrrev_b32 v5, 3, v3
    v_lshl_add_u32 v4, v5, 4, v4
    v_lshlrev_b32 v4, 13, v4
    v_and_b32 v13, 7, v3
    v_lshl_add_u32 v13, v13, 4, v4
    v_xor_b32 v14, 0x8000, v13
    s_lshl_b32 s68, s58, 20
    s_lshl_b32 s61, s57, 8
    s_add_u32 s68, s68, s61
    s_lshl_b32 s61, s3, 7
    s_add_u32 s68, s68, s61
    s_add_u32 s61, s68, 0
    buffer_load_dwordx4 v[48:51], v13, s[24:27], s61 offen nt
    s_add_u32 s61, s68, 0
    buffer_load_dwordx4 v[52:55], v14, s[24:27], s61 offen nt
    s_add_u32 s61, s68, 262144
    buffer_load_dwordx4 v[56:59], v13, s[24:27], s61 offen nt
    s_add_u32 s61, s68, 262144
    buffer_load_dwordx4 v[60:63], v14, s[24:27], s61 offen nt
    s_add_u32 s61, s68, 8192
    buffer_load_dwordx4 v[64:67], v13, s[24:27], s61 offen nt
    s_add_u32 s61, s68, 8192
    buffer_load_dwordx4 v[68:71], v14, s[24:27], s61 offen nt
    s_add_u32 s61, s68, 270336
    buffer_load_dwordx4 v[72:75], v13, s[24:27], s61 offen nt
    s_add_u32 s61, s68, 270336
    buffer_load_dwordx4 v[76:79], v14, s[24:27], s61 offen nt
    s_add_u32 s61, s68, 524288
    buffer_load_dwordx4 v[80:83], v13, s[24:27], s61 offen nt
    s_add_u32 s61, s68, 524288
    buffer_load_dwordx4 v[84:87], v14, s[24:27], s61 offen nt
    s_add_u32 s61, s68, 786432
    buffer_load_dwordx4 v[88:91], v13, s[24:27], s61 offen nt
    s_add_u32 s61, s68, 786432
    buffer_load_dwordx4 v[92:95], v14, s[24:27], s61 offen nt
    s_add_u32 s61, s68, 532480
    buffer_load_dwordx4 v[96:99], v13, s[24:27], s61 offen nt
    s_add_u32 s61, s68, 532480
    buffer_load_dwordx4 v[100:103], v14, s[24:27], s61 offen nt
    s_add_u32 s61, s68, 794624
    buffer_load_dwordx4 v[104:107], v13, s[24:27], s61 offen nt
    s_add_u32 s61, s68, 794624
    buffer_load_dwordx4 v[108:111], v14, s[24:27], s61 offen nt
    v_lshrrev_b32 v4, 2, v3
    v_and_b32 v4, 2, v4
    v_add_u32 v4, v4, v3
    v_and_b32 v4, 3, v4
    v_mul_u32_u24 v162, 256, v4
    v_bfe_u32 v4, v3, 2, 1
    v_mul_u32_u24 v4, 64, v4
    v_add_u32 v162, v162, v4
    v_mul_u32_u24 v4, 16, v2
    v_add_u32 v162, v162, v4
    v_add_u32 v162, 65792, v162
    s_nop 0
    s_branch L_D_ld
L_D_nod:
    v_lshrrev_b32 v4, 2, v3
    v_and_b32 v4, 2, v4
    v_add_u32 v4, v4, v3
    v_and_b32 v4, 3, v4
    v_mul_u32_u24 v162, 256, v4
    v_bfe_u32 v4, v3, 2, 1
    v_mul_u32_u24 v4, 64, v4
    v_add_u32 v162, v162, v4
    v_mul_u32_u24 v4, 16, v2
    v_add_u32 v162, v162, v4
    v_add_u32 v162, 67584, v162
    s_cmp_ge_u32 s3, s69
    s_cbranch_scc1 L_D_noe
    v_lshrrev_b32 v4, 3, v3
    v_lshlrev_b32 v4, 2, v4
    v_add_u32 v4, v4, v2
    v_mul_u32_u24 v4, 9216, v4
    v_and_b32 v14, 7, v3
    v_lshl_add_u32 v14, v14, 4, v4
    s_mul_i32 s68, s57, 147456
    s_lshl_b32 s61, s62, 7
    s_add_u32 s68, s68, s61
    s_mov_b32 s63, s68
    buffer_load_dword v12, v7, s[48:51], s64 offen
    buffer_load_dwordx4 v[112:115], v14, s[28:31], s63 offen nt
    s_add_u32 s63, s63, 1152
    buffer_load_dwordx4 v[116:119], v14, s[28:31], s63 offen nt
    s_add_u32 s63, s63, 1152
    buffer_load_dwordx4 v[120:123], v14, s[28:31], s63 offen nt
    s_add_u32 s63, s63, 1152
    buffer_load_dwordx4 v[124:127], v14, s[28:31], s63 offen nt
    s_add_u32 s63, s63, 1152
    s_cmp_lg_u32 s3, 4
    s_cbranch_scc1 L_D_ld
    buffer_load_dwordx4 v[128:131], v14, s[28:31], s63 offen nt
    s_add_u32 s63, s63, 1152
    buffer_load_dwordx4 v[132:135], v14, s[28:31], s63 offen nt
    s_add_u32 s63, s63, 1152
    buffer_load_dwordx4 v[136:139], v14, s[28:31], s63 offen nt
    s_add_u32 s63, s63, 1152
    buffer_load_dwordx4 v[140:143], v14, s[28:31], s63 offen nt
    s_add_u32 s63, s63, 65664
    buffer_load_dwordx4 v[48:51], v14, s[28:31], s63 offen nt
    s_add_u32 s63, s63, 1152
    buffer_load_dwordx4 v[52:55], v14, s[28:31], s63 offen nt
    s_add_u32 s63, s63, 1152
    buffer_load_dwordx4 v[56:59], v14, s[28:31], s63 offen nt
    s_add_u32 s63, s63, 1152
    buffer_load_dwordx4 v[60:63], v14, s[28:31], s63 offen nt
    s_add_u32 s63, s63, 1152
    buffer_load_dwordx4 v[64:67], v14, s[28:31], s63 offen nt
    s_add_u32 s63, s63, 1152
    buffer_load_dwordx4 v[68:71], v14, s[28:31], s63 offen nt
    s_add_u32 s63, s63, 1152
    buffer_load_dwordx4 v[72:75], v14, s[28:31], s63 offen nt
    s_add_u32 s63, s63, 1152
    buffer_load_dwordx4 v[76:79], v14, s[28:31], s63 offen nt
    s_branch L_D_ld
L_D_noe:
    s_cmp_lt_u32 s3, 8
    s_cbranch_scc1 L_D_ld
    v_lshlrev_b32 v4, 7, v1
    s_lshl_b32 s61, s57, 2
    s_add_u32 s61, s61, s58
    s_lshl_b32 s61, s61, 12
    s_add_u32 s61, s61, 2621440
    s_mov_b32 exec_hi, 0
    buffer_load_dword v48, v4, s[48:51], s61 offen
    s_mov_b64 exec, -1
L_D_ld:
    s_barrier
    s_add_u32 s61, s3, 0
    s_mov_b32 s59, 0xffff
    s_lshl_b32 s68, s61, 4
    s_mul_i32 s60, s61, 15
    s_add_u32 s60, s60, 5
    s_cmp_ge_u32 s61, 5
    s_cselect_b32 s59, 61439, s59
    s_cselect_b32 s68, s60, s68
    s_mul_i32 s60, s61, 12
    s_add_u32 s60, s60, 26
    s_cmp_ge_u32 s61, 7
    s_cselect_b32 s59, 4095, s59
    s_cselect_b32 s68, s60, s68
    s_mul_i32 s60, s61, 9
    s_add_u32 s60, s60, 50
    s_cmp_ge_u32 s61, 8
    s_cselect_b32 s59, 3822, s59
    s_cselect_b32 s68, s60, s68
    s_bfm_b32 s60, s5, 0
    s_and_b32 s60, s60, s59
    s_bcnt1_i32_b32 s60, s60
    s_add_u32 s68, s68, s60
    s_bitcmp1_b32 s59, s5
    s_cselect_b32 s68, s68, 250
    s_add_u32 s59, s68, 48
    s_cmp_ge_u32 s68, 144
    s_cselect_b32 s59, 250, s59
    s_cmp_ge_u32 s59, 162
    s_cbranch_scc1 L_ft_da
    s_cmp_ge_u32 s59, 81
    s_cselect_b32 s60, 81, 0
    s_sub_u32 s60, s59, s60
    s_lshl_b32 s60, s60, 6
    v_add_u32 v8, s60, v1
    v_mul_u32_u24 v9, 7282, v8
    v_lshrrev_b32 v9, 16, v9
    v_mul_u32_u24 v9, 63, v9
    v_add_u32 v8, v8, v9
    v_lshlrev_b32 v8, 7, v8
    s_mul_i32 s60, s4, 1152
    s_cmp_ge_u32 s59, 81
    s_cbranch_scc1 L_ft_ua
    buffer_load_dword v10, v8, s[32:35], s60 offen
    s_branch L_ft_ea
L_ft_ua:
    buffer_load_dword v10, v8, s[36:39], s60 offen
    s_branch L_ft_ea
L_ft_da:
    v_lshlrev_b32 v8, 7, v1
    s_mul_i32 s60, s4, 81
    s_add_u32 s60, s60, s59
    s_sub_u32 s60, s60, 162
    s_lshl_b32 s60, s60, 13
    s_cmp_ge_u32 s59, 243
    s_cselect_b32 s60, 5308416, s60
    buffer_load_dword v10, v8, s[40:43], s60 offen
L_ft_ea:
    s_barrier
    s_add_u32 s61, s3, 9
    s_mov_b32 s59, 0xffff
    s_lshl_b32 s68, s61, 4
    s_mul_i32 s60, s61, 15
    s_add_u32 s60, s60, 5
    s_cmp_ge_u32 s61, 5
    s_cselect_b32 s59, 61439, s59
    s_cselect_b32 s68, s60, s68
    s_mul_i32 s60, s61, 12
    s_add_u32 s60, s60, 26
    s_cmp_ge_u32 s61, 7
    s_cselect_b32 s59, 4095, s59
    s_cselect_b32 s68, s60, s68
    s_mul_i32 s60, s61, 9
    s_add_u32 s60, s60, 50
    s_cmp_ge_u32 s61, 8
    s_cselect_b32 s59, 3822, s59
    s_cselect_b32 s68, s60, s68
    s_bfm_b32 s60, s5, 0
    s_and_b32 s60, s60, s59
    s_bcnt1_i32_b32 s60, s60
    s_add_u32 s68, s68, s60
    s_bitcmp1_b32 s59, s5
    s_cselect_b32 s68, s68, 250
    s_add_u32 s59, s68, 48
    s_cmp_ge_u32 s68, 144
    s_cselect_b32 s59, 250, s59
    s_cmp_ge_u32 s59, 162
    s_cbranch_scc1 L_ft_db
    s_cmp_ge_u32 s59, 81
    s_cselect_b32 s60, 81, 0
    s_sub_u32 s60, s59, s60
    s_lshl_b32 s60, s60, 6
    v_add_u32 v8, s60, v1
    v_mul_u32_u24 v9, 7282, v8
    v_lshrrev_b32 v9, 16, v9
    v_mul_u32_u24 v9, 63, v9
    v_add_u32 v8, v8, v9
    v_lshlrev_b32 v8, 7, v8
    s_mul_i32 s60, s4, 1152
    s_cmp_ge_u32 s59, 81
    s_cbranch_scc1 L_ft_ub
    buffer_load_dword v11, v8, s[32:35], s60 offen
    s_branch L_ft_eb
L_ft_ub:
    buffer_load_dword v11, v8, s[36:39], s60 offen
    s_branch L_ft_eb
L_ft_db:
    v_lshlrev_b32 v8, 7, v1
    s_mul_i32 s60, s4, 81
    s_add_u32 s60, s60, s59
    s_sub_u32 s60, s60, 162
    s_lshl_b32 s60, s60, 13
    s_cmp_ge_u32 s59, 243
    s_cselect_b32 s60, 5308416, s60
    buffer_load_dword v11, v8, s[40:43], s60 offen
L_ft_eb:
    s_lshl_b32 s59, s57, 3
    s_lshl_b32 s61, s58, 1
    s_add_u32 s59, s59, s61
    s_and_b32 s61, s3, 1
    s_add_u32 s59, s59, s61
    s_mul_i32 s59, s59, 16512
    s_lshr_b32 s61, s3, 1
    s_lshl_b32 s61, s61, 12
    s_add_u32 s59, s59, s61
    s_add_u32 s59, s59, 3145728
    v_lshrrev_b32 v4, 3, v3
    v_lshlrev_b32 v4, 2, v4
    v_add_u32 v4, v4, v2
    v_mul_u32_u24 v4, 512, v4
    v_and_b32 v13, 7, v3
    v_lshl_add_u32 v13, v13, 4, v4
    v_bfe_u32 v4, v3, 2, 1
    v_lshlrev_b32 v4, 5, v4
    v_lshl_add_u32 v160, v2, 3, v4
    s_lshr_b32 s61, s3, 1
    s_lshl_b32 s61, s61, 6
    s_add_u32 s61, s61, 65536
    v_add_u32 v160, s61, v160
    v_and_b32 v4, 7, v1
    v_lshlrev_b32 v4, 4, v4
    v_lshl_add_u32 v161, v2, 3, v4
    s_lshl_b32 s61, s3, 7
    s_add_u32 s61, s61, 65792
    v_add_u32 v161, s61, v161
    s_lshl_b32 s65, s57, 14
    s_add_u32 s65, s65, 2097152
    v_lshlrev_b32 v6, 4, v1
    s_lshl_b32 s66, s58, 12
    s_add_u32 s66, s66, s65
    s_sub_u32 s67, s3, 5
    s_and_b32 s67, s67, 3
    v_and_b32 v5, 7, v1
    v_lshlrev_b32 v5, 4, v5
    v_lshl_add_u32 v5, v2, 8, v5
    v_and_b32 v4, 8, v1
    v_add_u32 v5, v5, v4
    s_lshr_b32 s61, s67, 1
    s_lshl_b32 s61, s61, 7
    s_and_b32 s68, s67, 1
    s_lshl_b32 s68, s68, 2
    s_add_u32 s61, s61, s68
    s_add_u32 s61, s61, 67584
    v_add_u32 v5, s61, v5
    s_lshl_b32 s67, s67, 10
    v_mov_b32 v145, s53
    v_mov_b32 v147, s53
    v_mov_b32 v149, s53
    v_mov_b32 v151, s53
    s_waitcnt vmcnt(2)
    s_cmp_ge_u32 s3, 4
    s_cbranch_scc1 L_P_nwt
L_P_nwt:
    s_cmp_ge_u32 s3, 2
    s_cbranch_scc1 L_D_np
    v_perm_b32 v112, v52, v48, s6
    v_perm_b32 v113, v60, v56, s6
    v_perm_b32 v114, v68, v64, s6
    v_perm_b32 v115, v76, v72, s6
    v_perm_b32 v116, v52, v48, s7
    v_perm_b32 v117, v60, v56, s7
    v_perm_b32 v118, v68, v64, s7
    v_perm_b32 v119, v76, v72, s7
    v_perm_b32 v120, v53, v49, s6
    v_perm_b32 v121, v61, v57, s6
    v_perm_b32 v122, v69, v65, s6
    v_perm_b32 v123, v77, v73, s6
    v_perm_b32 v124, v53, v49, s7
    v_perm_b32 v125, v61, v57, s7
    v_perm_b32 v126, v69, v65, s7
    v_perm_b32 v127, v77, v73, s7
    v_perm_b32 v128, v54, v50, s6
    v_perm_b32 v129, v62, v58, s6
    v_perm_b32 v130, v70, v66, s6
    v_perm_b32 v131, v78, v74, s6
    v_perm_b32 v132, v54, v50, s7
    v_perm_b32 v133, v62, v58, s7
    v_perm_b32 v134, v70, v66, s7
    v_perm_b32 v135, v78, v74, s7
    v_perm_b32 v136, v55, v51, s6
    v_perm_b32 v137, v63, v59, s6
    v_perm_b32 v138, v71, v67, s6
    v_perm_b32 v139, v79, v75, s6
    v_perm_b32 v140, v55, v51, s7
    v_perm_b32 v141, v63, v59, s7
    v_perm_b32 v142, v71, v67, s7
    v_perm_b32 v143, v79, v75, s7
    v_perm_b32 v48, v84, v80, s6
    v_perm_b32 v49, v92, v88, s6
    v_perm_b32 v50, v100, v96, s6
    v_perm_b32 v51, v108, v104, s6
    v_perm_b32 v52, v84, v80, s7
    v_perm_b32 v53, v92, v88, s7
    v_perm_b32 v54, v100, v96, s7
    v_perm_b32 v55, v108, v104, s7
    v_perm_b32 v56, v85, v81, s6
    v_perm_b32 v57, v93, v89, s6
    v_perm_b32 v58, v101, v97, s6
    v_perm_b32 v59, v109, v105, s6
    v_perm_b32 v60, v85, v81, s7
    v_perm_b32 v61, v93, v89, s7
    v_perm_b32 v62, v101, v97, s7
    v_perm_b32 v63, v109, v105, s7
    v_perm_b32 v64, v86, v82, s6
    v_perm_b32 v65, v94, v90, s6
    v_perm_b32 v66, v102, v98, s6
    v_perm_b32 v67, v110, v106, s6
    v_perm_b32 v68, v86, v82, s7
    v_perm_b32 v69, v94, v90, s7
    v_perm_b32 v70, v102, v98, s7
    v_perm_b32 v71, v110, v106, s7
    v_perm_b32 v72, v87, v83, s6
    v_perm_b32 v73, v95, v91, s6
    v_perm_b32 v74, v103, v99, s6
    v_perm_b32 v75, v111, v107, s6
    v_perm_b32 v76, v87, v83, s7
    v_perm_b32 v77, v95, v91, s7
    v_perm_b32 v78, v103, v99, s7
    v_perm_b32 v79, v111, v107, s7
    s_nop 1
L_D_np:
    s_cmp_eq_u32 s3, 8
    s_cbranch_scc1 L_D8
    s_and_b32 s61, s54, 1
    s_lshl_b32 s61, 0x11111111, s61
    s_and_b32 s60, s54, 0xcccccccc
    s_or_b32 s60, s60, s61
    v_and_b32 v4, 7, v1
    v_lshlrev_b32 v4, 2, v4
    v_lshrrev_b32 v4, v4, s60
    v_bfe_i32 v163, v4, 0, 1
    v_bfe_i32 v164, v4, 1, 1
    v_bfe_i32 v165, v4, 2, 1
    v_bfe_i32 v166, v4, 3, 1
    s_mov_b32 s55, 0
    s_mov_b32 s60, 0x00010001
    v_mov_b32 v155, 0x10000
    s_setprio 1
    s_barrier
    buffer_load_dwordx4 v[16:19], v13, s[48:51], s59 offen offset:0 sc1
    buffer_load_dwordx4 v[20:23], v13, s[48:51], s59 offen offset:128 sc1
    buffer_load_dwordx4 v[24:27], v13, s[48:51], s59 offen offset:256 sc1
    buffer_load_dwordx4 v[28:31], v13, s[48:51], s59 offen offset:384 sc1
    s_lshr_b32 s56, s3, 1
    s_cmp_lg_u32 s56, 1
    s_cbranch_scc1 L_D_nwo
    s_setprio 0
    buffer_load_dwordx4 v[128:131], v14, s[28:31], s63 offen nt
    s_add_u32 s63, s63, 1152
    buffer_load_dwordx4 v[132:135], v14, s[28:31], s63 offen nt
    s_add_u32 s63, s63, 1152
    buffer_load_dwordx4 v[136:139], v14, s[28:31], s63 offen nt
    s_add_u32 s63, s63, 1152
    buffer_load_dwordx4 v[140:143], v14, s[28:31], s63 offen nt
    s_add_u32 s63, s63, 65664
    buffer_load_dwordx4 v[48:51], v14, s[28:31], s63 offen nt
    s_add_u32 s63, s63, 1152
    buffer_load_dwordx4 v[52:55], v14, s[28:31], s63 offen nt
    s_add_u32 s63, s63, 1152
    buffer_load_dwordx4 v[56:59], v14, s[28:31], s63 offen nt
    s_add_u32 s63, s63, 1152
    buffer_load_dwordx4 v[60:63], v14, s[28:31], s63 offen nt
    s_add_u32 s63, s63, 1152
    buffer_load_dwordx4 v[64:67], v14, s[28:31], s63 offen nt
    s_add_u32 s63, s63, 1152
    buffer_load_dwordx4 v[68:71], v14, s[28:31], s63 offen nt
    s_add_u32 s63, s63, 1152
    buffer_load_dwordx4 v[72:75], v14, s[28:31], s63 offen nt
    s_add_u32 s63, s63, 1152
    buffer_load_dwordx4 v[76:79], v14, s[28:31], s63 offen nt
L_D_nwo:
    s_barrier
    ds_read_b64 v[152:153], v160
    s_cmp_eq_u32 s56, 1
    s_cbranch_scc1 L_D_wa
    s_waitcnt vmcnt(2)
L_D_wa:
    s_waitcnt vmcnt(14)
L_D_rt:
    v_perm_b32 v8, v20, v16, s6
    v_bfi_b32 v32, s60, v155, v8
    v_perm_b32 v34, v20, v16, s7
    v_perm_b32 v9, v21, v17, s6
    v_bfi_b32 v36, s60, v155, v9
    v_perm_b32 v38, v21, v17, s7
    v_perm_b32 v15, v22, v18, s6
    v_bfi_b32 v40, s60, v155, v15
    v_perm_b32 v42, v22, v18, s7
    v_perm_b32 v167, v23, v19, s6
    v_bfi_b32 v44, s60, v155, v167
    v_perm_b32 v46, v23, v19, s7
    s_cmp_eq_u32 s56, 1
    s_cbranch_scc1 L_D_wb
    s_waitcnt vmcnt(0)
L_D_wb:
    s_waitcnt vmcnt(12)
    s_waitcnt lgkmcnt(0)
    v_perm_b32 v35, v28, v24, s7
    v_perm_b32 v43, v30, v26, s7
    v_perm_b32 v156, v28, v24, s6
    v_bfi_b32 v33, s60, v155, v156
    v_mfma_f32_16x16x16_bf16 v[84:87], v[152:153], v[34:35], 0
    v_perm_b32 v158, v30, v26, s6
    v_bfi_b32 v41, s60, v155, v158
    v_mfma_f32_16x16x16_bf16 v[100:103], v[152:153], v[42:43], 0
    v_perm_b32 v39, v29, v25, s7
    v_mfma_f32_16x16x16_bf16 v[80:83], v[152:153], v[32:33], 0
    v_perm_b32 v47, v31, v27, s7
    v_mfma_f32_16x16x16_bf16 v[96:99], v[152:153], v[40:41], 0
    v_perm_b32 v157, v29, v25, s6
    v_bfi_b32 v37, s60, v155, v157
    v_mfma_f32_16x16x16_bf16 v[92:95], v[152:153], v[38:39], 0
    v_perm_b32 v159, v31, v27, s6
    v_bfi_b32 v45, s60, v155, v159
    v_mfma_f32_16x16x16_bf16 v[108:111], v[152:153], v[46:47], 0
    v_mfma_f32_16x16x16_bf16 v[88:91], v[152:153], v[36:37], 0
    v_mfma_f32_16x16x16_bf16 v[104:107], v[152:153], v[44:45], 0
    v_bitop3_b32 v156, v8, v156, v163 bitop3:0x7e
    v_bitop3_b32 v157, v9, v157, v164 bitop3:0x7e
    v_bitop3_b32 v158, v15, v158, v165 bitop3:0x7e
    v_bitop3_b32 v159, v167, v159, v166 bitop3:0x7e
    v_or3_b32 v156, v156, v157, v158
    v_or_b32 v156, v156, v159
    v_and_b32 v156, s60, v156
    v_cmp_ne_u32 vcc, 0, v156
    s_nop 0
    s_cbranch_vccnz L_D_bad
L_D_ok:
    v_permlane16_swap_b32 v84, v100
    v_permlane16_swap_b32 v80, v96
    v_permlane16_swap_b32 v92, v108
    v_permlane16_swap_b32 v88, v104
    v_add_f32_dpp v17, v100, v84 row_ror:8 row_mask:0xf bank_mask:0xf
    v_add_f32_dpp v16, v96, v80 row_ror:8 row_mask:0xf bank_mask:0xf
    v_add_f32_dpp v19, v108, v92 row_ror:8 row_mask:0xf bank_mask:0xf
    v_add_f32_dpp v18, v104, v88 row_ror:8 row_mask:0xf bank_mask:0xf
    v_cvt_pk_bf16_f32 v16, v16, v17
    v_cvt_pk_bf16_f32 v17, v18, v19
    s_mov_b32 exec_lo, 0x00ff00ff
    s_mov_b32 exec_hi, 0
    ds_write_b64 v161, v[16:17]
    s_mov_b64 exec, -1
    s_waitcnt lgkmcnt(0)
L_D_x3:
    s_barrier
    s_cmp_ge_u32 s3, 2
    s_cbranch_scc1 L_D_g
    s_lshl_b32 s61, s3, 11
    s_add_u32 s66, s66, s61
    s_add_u32 s61, s66, 524288
    ds_read_b128 v[152:155], v162
    ds_read_b128 v[156:159], v162 offset:128
    s_waitcnt lgkmcnt(1)
    v_mfma_f32_16x16x32_bf16 v[16:19], v[152:155], v[112:115], 0
    s_waitcnt lgkmcnt(0)
    v_mfma_f32_16x16x32_bf16 v[16:19], v[156:159], v[48:51], v[16:19]
    v_mfma_f32_16x16x32_bf16 v[32:35], v[152:155], v[128:131], 0
    v_mfma_f32_16x16x32_bf16 v[32:35], v[156:159], v[64:67], v[32:35]
    v_mfma_f32_16x16x32_bf16 v[20:23], v[152:155], v[116:119], 0
    v_mfma_f32_16x16x32_bf16 v[20:23], v[156:159], v[52:55], v[20:23]
    v_mfma_f32_16x16x32_bf16 v[36:39], v[152:155], v[132:135], 0
    v_mfma_f32_16x16x32_bf16 v[36:39], v[156:159], v[68:71], v[36:39]
    v_mfma_f32_16x16x32_bf16 v[24:27], v[152:155], v[120:123], 0
    v_mfma_f32_16x16x32_bf16 v[24:27], v[156:159], v[56:59], v[24:27]
    v_permlane16_swap_b32 v16, v17
    v_mfma_f32_16x16x32_bf16 v[40:43], v[152:155], v[136:139], 0
    v_permlane16_swap_b32 v32, v33
    v_mfma_f32_16x16x32_bf16 v[40:43], v[156:159], v[72:75], v[40:43]
    v_permlane16_swap_b32 v20, v21
    v_mfma_f32_16x16x32_bf16 v[28:31], v[152:155], v[124:127], 0
    v_add_f32_dpp v144, v17, v16 row_ror:8 row_mask:0xf bank_mask:0x3
    v_mfma_f32_16x16x32_bf16 v[28:31], v[156:159], v[60:63], v[28:31]
    v_permlane16_swap_b32 v36, v37
    v_mfma_f32_16x16x32_bf16 v[44:47], v[152:155], v[140:143], 0
    v_add_f32_dpp v144, v32, v33 row_ror:8 row_mask:0xf bank_mask:0xc
    v_mfma_f32_16x16x32_bf16 v[44:47], v[156:159], v[76:79], v[44:47]
    v_permlane16_swap_b32 v24, v25
    v_add_f32_dpp v146, v21, v20 row_ror:8 row_mask:0xf bank_mask:0x3
    v_permlane16_swap_b32 v40, v41
    s_nop 0
    v_add_f32_dpp v146, v36, v37 row_ror:8 row_mask:0xf bank_mask:0xc
    v_permlane16_swap_b32 v28, v29
    v_add_f32_dpp v148, v25, v24 row_ror:8 row_mask:0xf bank_mask:0x3
    s_nop 0
    v_permlane16_swap_b32 v44, v45
    v_add_f32_dpp v148, v40, v41 row_ror:8 row_mask:0xf bank_mask:0xc
    v_add_f32_dpp v150, v29, v28 row_ror:8 row_mask:0xf bank_mask:0x3
    s_nop 1
    v_add_f32_dpp v150, v44, v45 row_ror:8 row_mask:0xf bank_mask:0xc
    buffer_store_dwordx4 v[144:147], v6, s[48:51], s61 offen offset:0
    buffer_store_dwordx4 v[148:151], v6, s[48:51], s61 offen offset:1024
    s_barrier
    s_or_b32 s59, s2, s3
    s_cmp_lg_u32 s59, 0
    s_cbranch_scc1 L_D_noep
    v_mov_b32 v18, 0
    v_mov_b32 v19, s54
    s_mov_b64 exec, 1
    buffer_store_dword v19, v18, s[48:51], 0 offen offset:0 sc1
    s_mov_b64 exec, -1
L_D_noep:
    s_endpgm
L_D_bad:
    s_add_u32 s55, s55, 1
    s_cmp_ge_u32 s55, 524288
    s_cbranch_scc1 L_D_ok
    v_or_b32_dpp v156, v156, v156 quad_perm:[1,0,3,2] row_mask:0xf bank_mask:0xf
    s_nop 1
    v_or_b32_dpp v156, v156, v156 quad_perm:[2,3,0,1] row_mask:0xf bank_mask:0xf
    s_nop 1
    v_or_b32_dpp v156, v156, v156 row_half_mirror row_mask:0xf bank_mask:0xf
    v_cmp_ne_u32 vcc, 0, v156
    s_nop 0
    s_mov_b64 exec, vcc
    buffer_load_dwordx4 v[16:19], v13, s[48:51], s59 offen offset:0 sc1
    buffer_load_dwordx4 v[20:23], v13, s[48:51], s59 offen offset:128 sc1
    buffer_load_dwordx4 v[24:27], v13, s[48:51], s59 offen offset:256 sc1
    buffer_load_dwordx4 v[28:31], v13, s[48:51], s59 offen offset:384 sc1
    s_mov_b64 exec, -1
    s_waitcnt vmcnt(0)
    s_branch L_D_rt
L_D_g:
    s_cmp_ge_u32 s3, 5
    s_cbranch_scc1 L_D_g2
    s_waitcnt vmcnt(8)
    v_perm_b32 v80, v116, v112, s6
    v_perm_b32 v81, v124, v120, s6
    v_perm_b32 v82, v132, v128, s6
    v_perm_b32 v83, v140, v136, s6
    v_perm_b32 v84, v116, v112, s7
    v_perm_b32 v85, v124, v120, s7
    v_perm_b32 v86, v132, v128, s7
    v_perm_b32 v87, v140, v136, s7
    v_perm_b32 v88, v117, v113, s6
    v_perm_b32 v89, v125, v121, s6
    v_perm_b32 v90, v133, v129, s6
    v_perm_b32 v91, v141, v137, s6
    v_perm_b32 v92, v117, v113, s7
    v_perm_b32 v93, v125, v121, s7
    v_perm_b32 v94, v133, v129, s7
    v_perm_b32 v95, v141, v137, s7
    v_perm_b32 v96, v118, v114, s6
    v_perm_b32 v97, v126, v122, s6
    v_perm_b32 v98, v134, v130, s6
    v_perm_b32 v99, v142, v138, s6
    v_perm_b32 v100, v118, v114, s7
    v_perm_b32 v101, v126, v122, s7
    v_perm_b32 v102, v134, v130, s7
    v_perm_b32 v103, v142, v138, s7
    v_perm_b32 v104, v119, v115, s6
    v_perm_b32 v105, v127, v123, s6
    v_perm_b32 v106, v135, v131, s6
    v_perm_b32 v107, v143, v139, s6
    v_perm_b32 v108, v119, v115, s7
    v_perm_b32 v109, v127, v123, s7
    v_perm_b32 v110, v135, v131, s7
    v_perm_b32 v111, v143, v139, s7
    s_waitcnt vmcnt(0)
    v_perm_b32 v112, v52, v48, s6
    v_perm_b32 v113, v60, v56, s6
    v_perm_b32 v114, v68, v64, s6
    v_perm_b32 v115, v76, v72, s6
    v_perm_b32 v116, v52, v48, s7
    v_perm_b32 v117, v60, v56, s7
    v_perm_b32 v118, v68, v64, s7
    v_perm_b32 v119, v76, v72, s7
    v_perm_b32 v120, v53, v49, s6
    v_perm_b32 v121, v61, v57, s6
    v_perm_b32 v122, v69, v65, s6
    v_perm_b32 v123, v77, v73, s6
    v_perm_b32 v124, v53, v49, s7
    v_perm_b32 v125, v61, v57, s7
    v_perm_b32 v126, v69, v65, s7
    v_perm_b32 v127, v77, v73, s7
    v_perm_b32 v128, v54, v50, s6
    v_perm_b32 v129, v62, v58, s6
    v_perm_b32 v130, v70, v66, s6
    v_perm_b32 v131, v78, v74, s6
    v_perm_b32 v132, v54, v50, s7
    v_perm_b32 v133, v62, v58, s7
    v_perm_b32 v134, v70, v66, s7
    v_perm_b32 v135, v78, v74, s7
    v_perm_b32 v136, v55, v51, s6
    v_perm_b32 v137, v63, v59, s6
    v_perm_b32 v138, v71, v67, s6
    v_perm_b32 v139, v79, v75, s6
    v_perm_b32 v140, v55, v51, s7
    v_perm_b32 v141, v63, v59, s7
    v_perm_b32 v142, v71, v67, s7
    v_perm_b32 v143, v79, v75, s7
    v_mov_b32 v149, s54
    v_mov_b32 v151, s54
    s_nop 0
    s_branch L_D_e
L_D_g2:
    s_add_u32 s65, s65, s67
    s_add_u32 s66, s66, s67
    s_mov_b32 s55, 0
L_D_hd:
    s_add_u32 s61, s65, 524288
    s_mov_b32 s52, s53
    s_cmp_lt_u32 s55, 24
    s_cbranch_scc1 L_D_hl
    s_bitcmp1_b32 s55, 0
    s_cbranch_scc1 L_D_hl
    s_add_u32 s61, s66, 524288
    buffer_load_dwordx4 v[16:19], v6, s[48:51], s61 offen sc1
    s_mov_b32 s61, s65
    s_mov_b32 s52, s54
    s_waitcnt vmcnt(0)
    v_xor_b32 v32, s53, v17
    v_xor_b32 v33, s53, v19
    v_or_b32 v32, v32, v33
    v_cmp_ne_u32 vcc, 0, v32
    s_nop 0
    s_cbranch_vccnz L_D_hl
    v_mov_b32 v17, s54
    v_mov_b32 v19, s54
    buffer_store_dwordx4 v[16:19], v6, s[48:51], s66 offen sc1
    s_nop 1
L_D_hl:
    buffer_load_dwordx4 v[16:19], v6, s[48:51], s61 offen sc1
    s_add_u32 s61, s61, 4096
    buffer_load_dwordx4 v[20:23], v6, s[48:51], s61 offen sc1
    s_add_u32 s61, s61, 4096
    buffer_load_dwordx4 v[24:27], v6, s[48:51], s61 offen sc1
    s_add_u32 s61, s61, 4096
    buffer_load_dwordx4 v[28:31], v6, s[48:51], s61 offen sc1
    s_waitcnt vmcnt(0)
    v_min3_u32 v32, v17, v19, s52
    v_max3_u32 v33, v17, v19, s52
    v_min3_u32 v32, v32, v21, v23
    v_max3_u32 v33, v33, v21, v23
    v_min3_u32 v32, v32, v25, v27
    v_max3_u32 v33, v33, v25, v27
    v_min3_u32 v32, v32, v29, v31
    v_max3_u32 v33, v33, v29, v31
    v_cmp_ne_u32 vcc, v32, v33
    s_nop 0
    s_cbranch_vccz L_sd_2
    s_add_u32 s55, s55, 1
    s_cmp_lt_u32 s55, 524288
    s_cbranch_scc1 L_D_hd
L_sd_2:
    v_add_f32 v16, v16, v20
    v_add_f32 v24, v24, v28
    v_add_f32 v18, v18, v22
    v_add_f32 v26, v26, v30
    v_add_f32 v16, v16, v24
    v_add_f32 v18, v18, v26
    v_cvt_pk_bf16_f32 v16, v16, v18
    ds_write_b32 v5, v16
    s_waitcnt lgkmcnt(0)
L_D_e:
    s_barrier
    s_cmp_ge_u32 s3, s69
    s_cbranch_scc1 L_D_fin
    ds_read_b128 v[152:155], v162
    ds_read_b128 v[156:159], v162 offset:128
    s_waitcnt lgkmcnt(1)
    v_mfma_f32_16x16x32_bf16 v[16:19], v[152:155], v[80:83], 0
    s_waitcnt lgkmcnt(0)
    v_mfma_f32_16x16x32_bf16 v[16:19], v[156:159], v[112:115], v[16:19]
    v_mfma_f32_16x16x32_bf16 v[32:35], v[152:155], v[96:99], 0
    v_mfma_f32_16x16x32_bf16 v[32:35], v[156:159], v[128:131], v[32:35]
    v_mfma_f32_16x16x32_bf16 v[20:23], v[152:155], v[84:87], 0
    v_mfma_f32_16x16x32_bf16 v[20:23], v[156:159], v[116:119], v[20:23]
    v_mfma_f32_16x16x32_bf16 v[36:39], v[152:155], v[100:103], 0
    v_mfma_f32_16x16x32_bf16 v[36:39], v[156:159], v[132:135], v[36:39]
    v_mfma_f32_16x16x32_bf16 v[24:27], v[152:155], v[88:91], 0
    v_mfma_f32_16x16x32_bf16 v[24:27], v[156:159], v[120:123], v[24:27]
    v_permlane16_swap_b32 v16, v17
    v_mfma_f32_16x16x32_bf16 v[40:43], v[152:155], v[104:107], 0
    v_permlane16_swap_b32 v32, v33
    v_mfma_f32_16x16x32_bf16 v[40:43], v[156:159], v[136:139], v[40:43]
    v_permlane16_swap_b32 v20, v21
    v_mfma_f32_16x16x32_bf16 v[28:31], v[152:155], v[92:95], 0
    v_add_f32_dpp v144, v17, v16 row_ror:8 row_mask:0xf bank_mask:0x3
    v_mfma_f32_16x16x32_bf16 v[28:31], v[156:159], v[124:127], v[28:31]
    v_permlane16_swap_b32 v36, v37
    v_mfma_f32_16x16x32_bf16 v[44:47], v[152:155], v[108:111], 0
    v_add_f32_dpp v144, v32, v33 row_ror:8 row_mask:0xf bank_mask:0xc
    v_mfma_f32_16x16x32_bf16 v[44:47], v[156:159], v[140:143], v[44:47]
    v_permlane16_swap_b32 v24, v25
    v_add_f32_dpp v145, v21, v20 row_ror:8 row_mask:0xf bank_mask:0x3
    v_permlane16_swap_b32 v40, v41
    s_nop 0
    v_add_f32_dpp v145, v36, v37 row_ror:8 row_mask:0xf bank_mask:0xc
    v_permlane16_swap_b32 v28, v29
    v_add_f32_dpp v146, v25, v24 row_ror:8 row_mask:0xf bank_mask:0x3
    s_nop 0
    v_permlane16_swap_b32 v44, v45
    v_add_f32_dpp v146, v40, v41 row_ror:8 row_mask:0xf bank_mask:0xc
    v_add_f32_dpp v147, v29, v28 row_ror:8 row_mask:0xf bank_mask:0x3
    s_nop 1
    v_add_f32_dpp v147, v44, v45 row_ror:8 row_mask:0xf bank_mask:0xc
    v_cvt_pk_bf16_f32 v148, v144, v145
    v_cvt_pk_bf16_f32 v150, v146, v147
    buffer_store_dwordx4 v[148:151], v7, s[48:51], s64 offen sc1
    s_nop 1
L_D_fin:
    s_endpgm
L_D8:
    s_setprio 2
    v_lshlrev_b32 v26, 9, v1
    s_lshl_b32 s59, s57, 4
    s_add_u32 s59, s59, 851968
    s_add_u32 s60, s59, 32768
    s_lshl_b32 s61, s63, 9
    s_and_b32 s61, s61, 0x7fff
    s_add_u32 s61, s61, s59
    v_lshlrev_b32 v25, 13, v1
    s_mov_b32 s55, 0
    s_nop 0
L_pl0_4:
    s_mov_b64 exec, 1
    buffer_load_dwordx4 v[16:19], v25, s[48:51], s61 offen sc1
    s_waitcnt vmcnt(0)
    v_cmp_ne_u32 vcc, s54, v19
    s_mov_b64 exec, -1
    s_cbranch_vccz L_sd_5
    s_add_u32 s55, s55, 1
    s_cmp_lt_u32 s55, 524288
    s_cbranch_scc1 L_pl0_4
L_sd_5:
    s_mov_b64 vcc, -1
    s_mov_b32 s55, 0
L_pl_3:
    s_mov_b64 exec, vcc
    buffer_load_dwordx4 v[16:19], v26, s[48:51], s59 offen sc1
    buffer_load_dwordx4 v[20:23], v26, s[48:51], s60 offen sc1
    s_mov_b64 exec, -1
    s_waitcnt vmcnt(0)
    v_min3_u32 v24, v17, v19, s54
    v_max3_u32 v25, v17, v19, s54
    v_min3_u32 v24, v24, v21, v23
    v_max3_u32 v25, v25, v21, v23
    v_cmp_ne_u32 vcc, v24, v25
    s_nop 0
    s_cbranch_vccz L_sd_6
    s_add_u32 s55, s55, 1
    s_cmp_lt_u32 s55, 524288
    s_cbranch_scc1 L_pl_3
L_sd_6:
    s_barrier
    v_mov_b32 v17, v16
    v_mov_b32 v21, v20
    s_nop 0
    v_max_f32_dpp v17, v17, v17 row_ror:8 row_mask:0xf bank_mask:0xf
    v_max_f32_dpp v21, v21, v21 row_ror:8 row_mask:0xf bank_mask:0xf
    s_nop 0
    v_max_f32_dpp v17, v17, v17 row_ror:4 row_mask:0xf bank_mask:0xf
    v_max_f32_dpp v21, v21, v21 row_ror:4 row_mask:0xf bank_mask:0xf
    s_nop 0
    v_max_f32_dpp v17, v17, v17 row_ror:2 row_mask:0xf bank_mask:0xf
    v_max_f32_dpp v21, v21, v21 row_ror:2 row_mask:0xf bank_mask:0xf
    s_nop 0
    v_max_f32_dpp v17, v17, v17 row_ror:1 row_mask:0xf bank_mask:0xf
    v_max_f32_dpp v21, v21, v21 row_ror:1 row_mask:0xf bank_mask:0xf
    v_mov_b32 v19, v17
    s_nop 1
    v_permlane16_swap_b32 v17, v19
    v_max_f32 v17, v17, v19
    v_mov_b32 v23, v21
    s_nop 1
    v_permlane16_swap_b32 v21, v23
    v_max_f32 v21, v21, v23
    v_sub_f32 v16, v16, v17
    v_sub_f32 v20, v20, v21
    v_exp_f32 v16, v16
    v_exp_f32 v20, v20
    v_mul_f32 v18, v18, v16
    v_mul_f32 v22, v22, v20
    s_nop 0
    v_add_f32_dpp v18, v18, v18 row_ror:8 row_mask:0xf bank_mask:0xf
    v_add_f32_dpp v22, v22, v22 row_ror:8 row_mask:0xf bank_mask:0xf
    s_nop 0
    v_add_f32_dpp v18, v18, v18 row_ror:4 row_mask:0xf bank_mask:0xf
    v_add_f32_dpp v22, v22, v22 row_ror:4 row_mask:0xf bank_mask:0xf
    s_nop 0
    v_add_f32_dpp v18, v18, v18 row_ror:2 row_mask:0xf bank_mask:0xf
    v_add_f32_dpp v22, v22, v22 row_ror:2 row_mask:0xf bank_mask:0xf
    s_nop 0
    v_add_f32_dpp v18, v18, v18 row_ror:1 row_mask:0xf bank_mask:0xf
    v_add_f32_dpp v22, v22, v22 row_ror:1 row_mask:0xf bank_mask:0xf
    v_mov_b32 v19, v18
    s_nop 1
    v_permlane16_swap_b32 v18, v19
    v_add_f32 v18, v18, v19
    v_mov_b32 v23, v22
    s_nop 1
    v_permlane16_swap_b32 v22, v23
    v_add_f32 v22, v22, v23
    v_rcp_f32 v18, v18
    v_rcp_f32 v22, v22
    v_mul_f32 v16, v16, v18
    v_mul_f32 v17, v20, v22
    v_cvt_pk_bf16_f32 v16, v16, v17
    v_lshlrev_b32 v4, 1, v1
    v_add_u32 v4, 65536, v4
    ds_write_b16 v4, v16
    ds_write_b16_d16_hi v4, v16 offset:128
    s_waitcnt lgkmcnt(0)
    s_barrier
    s_branch L_D_x3
L_K_rest:
    s_load_dwordx4 s[24:27], s[0:1], 32
    s_load_dwordx8 s[36:43], s[0:1], 56
    s_load_dword s54, s[48:49], 0
    s_mov_b32 s6, 0x05040100
    s_mov_b32 s7, 0x07060302
    v_mul_u32_u24 v12, 528384, v2
    v_lshl_add_u32 v12, v3, 3, v12
    s_mul_i32 s65, s3, 16512
    s_lshl_b32 s61, s58, 7
    s_add_u32 s65, s65, s61
    s_add_u32 s65, s65, 3145728
    s_add_u32 s66, s65, 2113536
    v_and_b32 v4, 1, v3
    v_bfe_u32 v6, v3, 1, 2
    v_lshl_or_b32 v4, v6, 2, v4
    v_bfe_u32 v6, v3, 3, 1
    v_lshl_or_b32 v4, v6, 1, v4
    v_lshlrev_b32 v4, 4, v4
    v_lshl_or_b32 v4, v2, 8, v4
    v_lshl_or_b32 v15, v3, 10, v4
    v_add_u32 v6, s60, v15
    v_lshrrev_b32 v4, 2, v1
    v_and_b32 v160, 1, v4
    v_bfe_u32 v161, v4, 1, 2
    v_lshl_or_b32 v160, v161, 2, v160
    v_bfe_u32 v161, v4, 3, 1
    v_lshl_or_b32 v160, v161, 1, v160
    v_and_b32 v161, 3, v1
    v_xor_b32 v160, v160, v161
    s_and_b32 s59, s3, 1
    s_lshl_b32 s59, s59, 3
    v_xor_b32 v160, s59, v160
    v_lshlrev_b32 v160, 4, v160
    v_lshl_or_b32 v160, v4, 10, v160
    v_and_b32 v161, 1, v1
    v_lshl_or_b32 v160, v161, 3, v160
    s_lshr_b32 s59, s3, 1
    s_lshl_b32 s59, s59, 8
    v_or_b32 v160, s59, v160
    v_xor_b32 v161, 8, v160
    v_xor_b32 v162, 64, v160
    v_xor_b32 v163, 72, v160
    s_lshr_b32 s63, s4, 1
    s_lshl_b32 s63, s63, 16
    s_and_b32 s61, s3, 3
    s_lshl_b32 s61, s61, 14
    s_add_u32 s63, s63, s61
    s_lshr_b32 s61, s3, 2
    s_lshl_b32 s61, s61, 10
    s_add_u32 s63, s63, s61
    s_add_u32 s63, s63, 589824
    v_lshrrev_b32 v4, 3, v1
    v_and_b32 v9, 7, v1
    v_lshlrev_b32 v9, 4, v9
    v_lshl_add_u32 v9, v4, 11, v9
    v_and_b32 v8, 6, v1
    v_xor_b32 v4, v4, v8
    v_lshlrev_b32 v4, 4, v4
    v_lshl_add_u32 v4, v8, 9, v4
    v_and_b32 v8, 1, v1
    v_lshl_add_u32 v8, v8, 3, v4
    s_and_b32 s59, s3, 1
    s_lshl_b32 s59, s59, 7
    s_and_b32 s61, s3, 2
    s_lshl_b32 s61, s61, 13
    s_add_u32 s59, s59, s61
    s_lshr_b32 s61, s3, 2
    s_lshl_b32 s61, s61, 9
    s_add_u32 s59, s59, s61
    s_add_u32 s59, s59, 131072
    v_add_u32 v8, s59, v8
    v_add_u32 v5, 131072, v5
    v_xor_b32 v7, 32, v5
    v_xor_b32 v13, 64, v5
    v_xor_b32 v15, 96, v5
    s_lshr_b32 s59, s3, 1
    s_lshl_b32 s59, s59, 11
    s_and_b32 s61, s3, 1
    s_lshl_b32 s61, s61, 3
    s_add_u32 s59, s59, s61
    v_lshl_add_u32 v166, v1, 4, s59
    v_lshlrev_b32 v165, 2, v3
    s_lshr_b32 s69, s3, 1
    s_mov_b32 s55, 0
    s_waitcnt vmcnt(0)
    s_add_u32 m0, s67, 8192
    s_add_u32 s68, s68, 8192
    buffer_load_dwordx4 v11, s[12:15], s68 offen nt lds
    s_add_u32 m0, s67, 16384
    s_add_u32 s68, s68, 8192
    buffer_load_dwordx4 v10, s[12:15], s68 offen nt lds
    s_add_u32 m0, s67, 24576
    s_add_u32 s68, s68, 8192
    buffer_load_dwordx4 v11, s[12:15], s68 offen nt lds
    s_waitcnt vmcnt(3)
    s_add_u32 m0, s67, 32768
    s_add_u32 s68, s68, 8192
    buffer_load_dwordx4 v10, s[12:15], s68 offen nt lds
    s_waitcnt vmcnt(3)
    s_add_u32 m0, s67, 40960
    s_add_u32 s68, s68, 8192
    buffer_load_dwordx4 v11, s[12:15], s68 offen nt lds
    s_waitcnt vmcnt(3)
    s_add_u32 m0, s67, 49152
    s_add_u32 s68, s68, 8192
    buffer_load_dwordx4 v10, s[12:15], s68 offen nt lds
    s_waitcnt vmcnt(3)
    s_add_u32 m0, s67, 57344
    s_add_u32 s68, s68, 8192
    buffer_load_dwordx4 v11, s[12:15], s68 offen nt lds
    s_barrier
    s_cmp_lg_u32 s69, 0
    s_cbranch_scc1 L_K_nb0
    v_xor_b32 v4, 0, v6
    ds_read_b128 v[16:19], v4
    v_xor_b32 v4, 16, v6
    ds_read_b128 v[20:23], v4
    v_xor_b32 v4, 32, v6
    ds_read_b128 v[24:27], v4
    v_xor_b32 v4, 48, v6
    ds_read_b128 v[28:31], v4
    v_xor_b32 v4, 64, v6
    ds_read_b128 v[32:35], v4
    v_xor_b32 v4, 80, v6
    ds_read_b128 v[36:39], v4
    v_xor_b32 v4, 96, v6
    ds_read_b128 v[40:43], v4
    v_xor_b32 v4, 112, v6
    ds_read_b128 v[44:47], v4
    v_xor_b32 v4, 128, v6
    ds_read_b128 v[48:51], v4
    v_xor_b32 v4, 144, v6
    ds_read_b128 v[52:55], v4
    v_xor_b32 v4, 160, v6
    ds_read_b128 v[56:59], v4
    v_xor_b32 v4, 176, v6
    ds_read_b128 v[60:63], v4
    v_xor_b32 v4, 192, v6
    ds_read_b128 v[64:67], v4
    v_xor_b32 v4, 208, v6
    ds_read_b128 v[68:71], v4
    v_xor_b32 v4, 224, v6
    ds_read_b128 v[72:75], v4
    v_xor_b32 v4, 240, v6
    ds_read_b128 v[76:79], v4
    s_nop 0
L_K_nb0:
    ds_read_b64_tr_b16 v[112:113], v160 offset:0
    ds_read_b64_tr_b16 v[114:115], v160 offset:16384
    ds_read_b64_tr_b16 v[116:117], v161 offset:0
    ds_read_b64_tr_b16 v[118:119], v161 offset:16384
    ds_read_b64_tr_b16 v[120:121], v162 offset:0
    ds_read_b64_tr_b16 v[122:123], v162 offset:16384
    ds_read_b64_tr_b16 v[124:125], v163 offset:0
    ds_read_b64_tr_b16 v[126:127], v163 offset:16384
    s_waitcnt vmcnt(3)
    s_add_u32 m0, s67, 65536
    s_add_u32 s68, s68, 8192
    buffer_load_dwordx4 v10, s[12:15], s68 offen nt lds
    s_waitcnt vmcnt(3)
    s_add_u32 m0, s67, 73728
    s_add_u32 s68, s68, 8192
    buffer_load_dwordx4 v11, s[12:15], s68 offen nt lds
    s_waitcnt vmcnt(3)
    s_add_u32 m0, s67, 81920
    s_add_u32 s68, s68, 8192
    buffer_load_dwordx4 v10, s[12:15], s68 offen nt lds
    s_waitcnt vmcnt(3)
    s_add_u32 m0, s67, 90112
    s_add_u32 s68, s68, 8192
    buffer_load_dwordx4 v11, s[12:15], s68 offen nt lds
    s_waitcnt lgkmcnt(0)
    s_mov_b64 s[28:29], s[26:27]
    s_mov_b64 s[32:33], s[36:37]
    s_mov_b64 s[36:37], s[38:39]
    s_mov_b64 s[44:45], s[42:43]
    s_mov_b32 s26, 4194304
    s_mov_b32 s27, 0x20000
    s_mov_b32 s30, 4718592
    s_mov_b32 s31, 0x20000
    s_mov_b32 s34, 5308416
    s_mov_b32 s35, 0x20000
    s_mov_b32 s38, 5308416
    s_mov_b32 s39, 0x20000
    s_mov_b32 s42, 5308416
    s_mov_b32 s43, 0x20000
    s_mov_b32 s46, 4608
    s_mov_b32 s47, 0x20000
    s_mul_i32 s54, s54, 1664525
    s_add_u32 s54, s54, 1013904223
    s_barrier
    s_cmp_lg_u32 s69, 1
    s_cbranch_scc1 L_K_nb1
    v_xor_b32 v4, 0, v6
    ds_read_b128 v[16:19], v4
    v_xor_b32 v4, 16, v6
    ds_read_b128 v[20:23], v4
    v_xor_b32 v4, 32, v6
    ds_read_b128 v[24:27], v4
    v_xor_b32 v4, 48, v6
    ds_read_b128 v[28:31], v4
    v_xor_b32 v4, 64, v6
    ds_read_b128 v[32:35], v4
    v_xor_b32 v4, 80, v6
    ds_read_b128 v[36:39], v4
    v_xor_b32 v4, 96, v6
    ds_read_b128 v[40:43], v4
    v_xor_b32 v4, 112, v6
    ds_read_b128 v[44:47], v4
    v_xor_b32 v4, 128, v6
    ds_read_b128 v[48:51], v4
    v_xor_b32 v4, 144, v6
    ds_read_b128 v[52:55], v4
    v_xor_b32 v4, 160, v6
    ds_read_b128 v[56:59], v4
    v_xor_b32 v4, 176, v6
    ds_read_b128 v[60:63], v4
    v_xor_b32 v4, 192, v6
    ds_read_b128 v[64:67], v4
    v_xor_b32 v4, 208, v6
    ds_read_b128 v[68:71], v4
    v_xor_b32 v4, 224, v6
    ds_read_b128 v[72:75], v4
    v_xor_b32 v4, 240, v6
    ds_read_b128 v[76:79], v4
    s_nop 0
L_K_nb1:
    ds_read_b64_tr_b16 v[128:129], v160 offset:32768
    ds_read_b64_tr_b16 v[130:131], v160 offset:49152
    ds_read_b64_tr_b16 v[132:133], v161 offset:32768
    ds_read_b64_tr_b16 v[134:135], v161 offset:49152
    ds_read_b64_tr_b16 v[136:137], v162 offset:32768
    ds_read_b64_tr_b16 v[138:139], v162 offset:49152
    ds_read_b64_tr_b16 v[140:141], v163 offset:32768
    ds_read_b64_tr_b16 v[142:143], v163 offset:49152
    s_waitcnt vmcnt(3)
    s_add_u32 m0, s67, 98304
    s_add_u32 s68, s68, 8192
    buffer_load_dwordx4 v10, s[12:15], s68 offen nt lds
    s_waitcnt vmcnt(3)
    s_add_u32 m0, s67, 106496
    s_add_u32 s68, s68, 8192
    buffer_load_dwordx4 v11, s[12:15], s68 offen nt lds
    s_waitcnt vmcnt(3)
    s_add_u32 m0, s67, 114688
    s_add_u32 s68, s68, 8192
    buffer_load_dwordx4 v10, s[12:15], s68 offen nt lds
    s_waitcnt vmcnt(3)
    s_add_u32 m0, s67, 122880
    s_add_u32 s68, s68, 8192
    buffer_load_dwordx4 v11, s[12:15], s68 offen nt lds
    s_barrier
    s_cmp_lg_u32 s69, 2
    s_cbranch_scc1 L_K_nb2
    v_xor_b32 v4, 0, v6
    ds_read_b128 v[16:19], v4
    v_xor_b32 v4, 16, v6
    ds_read_b128 v[20:23], v4
    v_xor_b32 v4, 32, v6
    ds_read_b128 v[24:27], v4
    v_xor_b32 v4, 48, v6
    ds_read_b128 v[28:31], v4
    v_xor_b32 v4, 64, v6
    ds_read_b128 v[32:35], v4
    v_xor_b32 v4, 80, v6
    ds_read_b128 v[36:39], v4
    v_xor_b32 v4, 96, v6
    ds_read_b128 v[40:43], v4
    v_xor_b32 v4, 112, v6
    ds_read_b128 v[44:47], v4
    v_xor_b32 v4, 128, v6
    ds_read_b128 v[48:51], v4
    v_xor_b32 v4, 144, v6
    ds_read_b128 v[52:55], v4
    v_xor_b32 v4, 160, v6
    ds_read_b128 v[56:59], v4
    v_xor_b32 v4, 176, v6
    ds_read_b128 v[60:63], v4
    v_xor_b32 v4, 192, v6
    ds_read_b128 v[64:67], v4
    v_xor_b32 v4, 208, v6
    ds_read_b128 v[68:71], v4
    v_xor_b32 v4, 224, v6
    ds_read_b128 v[72:75], v4
    v_xor_b32 v4, 240, v6
    ds_read_b128 v[76:79], v4
    s_nop 0
L_K_nb2:
    v_xor_b32 v160, 0x10000, v160
    ds_read_b64_tr_b16 v[144:145], v160 offset:0
    ds_read_b64_tr_b16 v[146:147], v160 offset:16384
    v_xor_b32 v161, 0x10000, v161
    ds_read_b64_tr_b16 v[148:149], v161 offset:0
    ds_read_b64_tr_b16 v[150:151], v161 offset:16384
    v_xor_b32 v162, 0x10000, v162
    ds_read_b64_tr_b16 v[152:153], v162 offset:0
    ds_read_b64_tr_b16 v[154:155], v162 offset:16384
    v_xor_b32 v163, 0x10000, v163
    ds_read_b64_tr_b16 v[156:157], v163 offset:0
    ds_read_b64_tr_b16 v[158:159], v163 offset:16384
    s_waitcnt vmcnt(2)
    buffer_load_dwordx4 v[80:83], v9, s[48:51], s63 offen offset:0 sc1
    buffer_load_dwordx4 v[84:87], v9, s[48:51], s63 offen offset:128 sc1
    buffer_load_dwordx4 v[88:91], v9, s[48:51], s63 offen offset:256 sc1
    buffer_load_dwordx4 v[92:95], v9, s[48:51], s63 offen offset:384 sc1
    buffer_load_dwordx4 v[96:99], v9, s[48:51], s63 offen offset:512 sc1
    buffer_load_dwordx4 v[100:103], v9, s[48:51], s63 offen offset:640 sc1
    buffer_load_dwordx4 v[104:107], v9, s[48:51], s63 offen offset:768 sc1
    buffer_load_dwordx4 v[108:111], v9, s[48:51], s63 offen offset:896 sc1
    s_waitcnt vmcnt(8)
    s_barrier
    s_cmp_lg_u32 s69, 3
    s_cbranch_scc1 L_K_nb3
    v_xor_b32 v4, 0, v6
    ds_read_b128 v[16:19], v4
    v_xor_b32 v4, 16, v6
    ds_read_b128 v[20:23], v4
    v_xor_b32 v4, 32, v6
    ds_read_b128 v[24:27], v4
    v_xor_b32 v4, 48, v6
    ds_read_b128 v[28:31], v4
    v_xor_b32 v4, 64, v6
    ds_read_b128 v[32:35], v4
    v_xor_b32 v4, 80, v6
    ds_read_b128 v[36:39], v4
    v_xor_b32 v4, 96, v6
    ds_read_b128 v[40:43], v4
    v_xor_b32 v4, 112, v6
    ds_read_b128 v[44:47], v4
    v_xor_b32 v4, 128, v6
    ds_read_b128 v[48:51], v4
    v_xor_b32 v4, 144, v6
    ds_read_b128 v[52:55], v4
    v_xor_b32 v4, 160, v6
    ds_read_b128 v[56:59], v4
    v_xor_b32 v4, 176, v6
    ds_read_b128 v[60:63], v4
    v_xor_b32 v4, 192, v6
    ds_read_b128 v[64:67], v4
    v_xor_b32 v4, 208, v6
    ds_read_b128 v[68:71], v4
    v_xor_b32 v4, 224, v6
    ds_read_b128 v[72:75], v4
    v_xor_b32 v4, 240, v6
    ds_read_b128 v[76:79], v4
    s_nop 0
L_K_nb3:
    s_waitcnt vmcnt(0)
    s_branch L_K_qchk
L_K_qld:
    s_mov_b64 exec, vcc
    buffer_load_dwordx4 v[80:83], v9, s[48:51], s63 offen offset:0 sc1
    buffer_load_dwordx4 v[84:87], v9, s[48:51], s63 offen offset:128 sc1
    buffer_load_dwordx4 v[88:91], v9, s[48:51], s63 offen offset:256 sc1
    buffer_load_dwordx4 v[92:95], v9, s[48:51], s63 offen offset:384 sc1
    buffer_load_dwordx4 v[96:99], v9, s[48:51], s63 offen offset:512 sc1
    buffer_load_dwordx4 v[100:103], v9, s[48:51], s63 offen offset:640 sc1
    buffer_load_dwordx4 v[104:107], v9, s[48:51], s63 offen offset:768 sc1
    buffer_load_dwordx4 v[108:111], v9, s[48:51], s63 offen offset:896 sc1
    s_mov_b64 exec, -1
    s_waitcnt vmcnt(0)
L_K_qchk:
    v_min3_u32 v4, v81, v83, s54
    v_max3_u32 v14, v81, v83, s54
    v_min3_u32 v4, v4, v85, v87
    v_max3_u32 v14, v14, v85, v87
    v_min3_u32 v4, v4, v89, v91
    v_max3_u32 v14, v14, v89, v91
    v_min3_u32 v4, v4, v93, v95
    v_max3_u32 v14, v14, v93, v95
    v_min3_u32 v4, v4, v97, v99
    v_max3_u32 v14, v14, v97, v99
    v_min3_u32 v4, v4, v101, v103
    v_max3_u32 v14, v14, v101, v103
    v_min3_u32 v4, v4, v105, v107
    v_max3_u32 v14, v14, v105, v107
    v_min3_u32 v4, v4, v109, v111
    v_max3_u32 v14, v14, v109, v111
    v_cmp_ne_u32 vcc, v4, v14
    s_nop 0
    s_cbranch_vccz L_K_qok
    s_sleep 1
    s_add_u32 s55, s55, 1
    s_cmp_lt_u32 s55, 524288
    s_cbranch_scc1 L_K_qld
L_K_qok:
    v_mov_b32 v81, v82
    ds_write_b64 v8, v[80:81] offset:0
    v_mov_b32 v85, v86
    ds_write_b64 v8, v[84:85] offset:4096
    v_mov_b32 v89, v90
    ds_write_b64 v8, v[88:89] offset:8192
    v_mov_b32 v93, v94
    ds_write_b64 v8, v[92:93] offset:12288
    v_mov_b32 v97, v98
    ds_write_b64 v8, v[96:97] offset:256
    v_mov_b32 v101, v102
    ds_write_b64 v8, v[100:101] offset:4352
    v_mov_b32 v105, v106
    ds_write_b64 v8, v[104:105] offset:8448
    v_mov_b32 v109, v110
    ds_write_b64 v8, v[108:109] offset:12544
    v_lshlrev_b32 v14, 4, v1
    s_and_b32 s61, s54, 1
    s_lshl_b32 s61, 0x11111111, s61
    s_and_b32 s59, s54, 0xcccccccc
    s_or_b32 s59, s59, s61
    v_lshlrev_b32 v4, 1, v3
    v_lshrrev_b32 v4, v4, s59
    v_bfe_u32 v6, v4, 1, 1
    v_and_b32 v4, 1, v4
    s_setprio 1
    s_waitcnt lgkmcnt(0)
    s_barrier
    s_mov_b32 s59, 0x3e0293ee
    ds_read_b128 v[80:83], v5 offset:0
    ds_read_b128 v[84:87], v7 offset:1024
    ds_read_b128 v[88:91], v13 offset:2048
    ds_read_b128 v[92:95], v15 offset:3072
    ds_read_b128 v[96:99], v5 offset:4096
    s_setprio 0
    ds_read_b128 v[100:103], v7 offset:5120
    s_waitcnt lgkmcnt(5)
    v_mfma_f32_16x16x32_bf16 v[104:107], v[16:19], v[80:83], 0
    ds_read_b128 v[80:83], v13 offset:6144
    s_waitcnt lgkmcnt(5)
    v_mfma_f32_16x16x32_bf16 v[104:107], v[20:23], v[84:87], v[104:107]
    ds_read_b128 v[84:87], v15 offset:7168
    s_waitcnt lgkmcnt(5)
    v_mfma_f32_16x16x32_bf16 v[104:107], v[24:27], v[88:91], v[104:107]
    ds_read_b128 v[88:91], v5 offset:8192
    s_waitcnt lgkmcnt(5)
    v_mfma_f32_16x16x32_bf16 v[104:107], v[28:31], v[92:95], v[104:107]
    ds_read_b128 v[92:95], v7 offset:9216
    s_waitcnt lgkmcnt(5)
    v_mfma_f32_16x16x32_bf16 v[104:107], v[32:35], v[96:99], v[104:107]
    ds_read_b128 v[96:99], v13 offset:10240
    s_waitcnt lgkmcnt(5)
    v_mfma_f32_16x16x32_bf16 v[104:107], v[36:39], v[100:103], v[104:107]
    ds_read_b128 v[100:103], v15 offset:11264
    s_waitcnt lgkmcnt(5)
    v_mfma_f32_16x16x32_bf16 v[104:107], v[40:43], v[80:83], v[104:107]
    ds_read_b128 v[80:83], v5 offset:12288
    s_waitcnt lgkmcnt(5)
    v_mfma_f32_16x16x32_bf16 v[104:107], v[44:47], v[84:87], v[104:107]
    ds_read_b128 v[84:87], v7 offset:13312
    s_waitcnt lgkmcnt(5)
    v_mfma_f32_16x16x32_bf16 v[104:107], v[48:51], v[88:91], v[104:107]
    ds_read_b128 v[88:91], v13 offset:14336
    s_waitcnt lgkmcnt(5)
    v_mfma_f32_16x16x32_bf16 v[104:107], v[52:55], v[92:95], v[104:107]
    ds_read_b128 v[92:95], v15 offset:15360
    s_waitcnt lgkmcnt(5)
    v_mfma_f32_16x16x32_bf16 v[104:107], v[56:59], v[96:99], v[104:107]
    ds_read_b128 v[96:99], v5 offset:16384
    s_waitcnt lgkmcnt(5)
    v_mfma_f32_16x16x32_bf16 v[104:107], v[60:63], v[100:103], v[104:107]
    ds_read_b128 v[100:103], v7 offset:17408
    s_waitcnt lgkmcnt(5)
    v_mfma_f32_16x16x32_bf16 v[104:107], v[64:67], v[80:83], v[104:107]
    ds_read_b128 v[80:83], v13 offset:18432
    s_waitcnt lgkmcnt(5)
    v_mfma_f32_16x16x32_bf16 v[104:107], v[68:71], v[84:87], v[104:107]
    ds_read_b128 v[84:87], v15 offset:19456
    s_waitcnt lgkmcnt(5)
    v_mfma_f32_16x16x32_bf16 v[104:107], v[72:75], v[88:91], v[104:107]
    ds_read_b128 v[88:91], v5 offset:20480
    s_waitcnt lgkmcnt(5)
    v_mfma_f32_16x16x32_bf16 v[104:107], v[76:79], v[92:95], v[104:107]
    ds_read_b128 v[92:95], v7 offset:21504
    s_waitcnt lgkmcnt(5)
    v_mfma_f32_16x16x32_bf16 v[108:111], v[16:19], v[96:99], 0
    ds_read_b128 v[96:99], v13 offset:22528
    s_waitcnt lgkmcnt(5)
    v_mfma_f32_16x16x32_bf16 v[108:111], v[20:23], v[100:103], v[108:111]
    ds_read_b128 v[100:103], v15 offset:23552
    s_waitcnt lgkmcnt(5)
    v_mfma_f32_16x16x32_bf16 v[108:111], v[24:27], v[80:83], v[108:111]
    v_max3_f32 v8, v104, v105, v106
    v_max_f32 v8, v8, v107
    ds_read_b128 v[80:83], v5 offset:24576
    s_waitcnt lgkmcnt(5)
    v_mfma_f32_16x16x32_bf16 v[108:111], v[28:31], v[84:87], v[108:111]
    v_mul_f32 v8, s59, v8
    ds_max_f32 v165, v8 offset:0
    ds_read_b128 v[84:87], v7 offset:25600
    s_waitcnt lgkmcnt(6)
    v_mfma_f32_16x16x32_bf16 v[108:111], v[32:35], v[88:91], v[108:111]
    ds_read_b128 v[88:91], v13 offset:26624
    s_waitcnt lgkmcnt(6)
    v_mfma_f32_16x16x32_bf16 v[108:111], v[36:39], v[92:95], v[108:111]
    ds_read_b128 v[92:95], v15 offset:27648
    s_waitcnt lgkmcnt(6)
    v_mfma_f32_16x16x32_bf16 v[108:111], v[40:43], v[96:99], v[108:111]
    ds_read_b128 v[96:99], v5 offset:28672
    s_waitcnt lgkmcnt(6)
    v_mfma_f32_16x16x32_bf16 v[108:111], v[44:47], v[100:103], v[108:111]
    ds_read_b128 v[100:103], v7 offset:29696
    s_waitcnt lgkmcnt(6)
    v_mfma_f32_16x16x32_bf16 v[108:111], v[48:51], v[80:83], v[108:111]
    s_waitcnt lgkmcnt(5)
    s_barrier
    ds_read_b32 v9, v165 offset:0
    ds_read_b128 v[80:83], v13 offset:30720
    s_waitcnt lgkmcnt(6)
    v_mfma_f32_16x16x32_bf16 v[108:111], v[52:55], v[84:87], v[108:111]
    ds_read_b128 v[84:87], v15 offset:31744
    s_waitcnt lgkmcnt(6)
    v_mfma_f32_16x16x32_bf16 v[108:111], v[56:59], v[88:91], v[108:111]
    ds_read_b64_tr_b16 v[88:89], v160 offset:32768
    ds_read_b64_tr_b16 v[90:91], v160 offset:49152
    s_waitcnt lgkmcnt(7)
    v_mfma_f32_16x16x32_bf16 v[108:111], v[60:63], v[92:95], v[108:111]
    ds_read_b64_tr_b16 v[92:93], v161 offset:32768
    ds_read_b64_tr_b16 v[94:95], v161 offset:49152
    s_waitcnt lgkmcnt(8)
    v_mfma_f32_16x16x32_bf16 v[108:111], v[64:67], v[96:99], v[108:111]
    s_waitcnt lgkmcnt(6)
    v_fma_f32 v104, v104, s59, -v9
    v_fma_f32 v105, v105, s59, -v9
    ds_read_b64_tr_b16 v[96:97], v162 offset:32768
    ds_read_b64_tr_b16 v[98:99], v162 offset:49152
    s_waitcnt lgkmcnt(9)
    v_mfma_f32_16x16x32_bf16 v[108:111], v[68:71], v[100:103], v[108:111]
    v_fma_f32 v106, v106, s59, -v9
    v_fma_f32 v107, v107, s59, -v9
    ds_read_b64_tr_b16 v[100:101], v163 offset:32768
    ds_read_b64_tr_b16 v[102:103], v163 offset:49152
    s_waitcnt lgkmcnt(9)
    v_mfma_f32_16x16x32_bf16 v[108:111], v[72:75], v[80:83], v[108:111]
    v_exp_f32 v104, v104
    s_waitcnt lgkmcnt(8)
    v_mfma_f32_16x16x32_bf16 v[108:111], v[76:79], v[84:87], v[108:111]
    v_exp_f32 v105, v105
    v_exp_f32 v106, v106
    v_exp_f32 v107, v107
    v_cvt_pk_bf16_f32 v10, v104, v105
    v_cvt_pk_bf16_f32 v11, v106, v107
    ds_write_b64 v166, v[10:11] offset:4096
    s_nop 1
    v_max3_f32 v8, v108, v109, v110
    v_max_f32 v8, v8, v111
    v_mul_f32 v8, s59, v8
    ds_max_f32 v165, v8 offset:64
    s_waitcnt lgkmcnt(0)
    s_barrier
    ds_read_b128 v[16:19], v14 offset:4096
    ds_read_b32 v164, v165 offset:64
    ds_read_b128 v[20:23], v14 offset:6144
    ds_read_b128 v[24:27], v14 offset:8192
    ds_read_b128 v[28:31], v14 offset:10240
    s_waitcnt lgkmcnt(4)
    v_mfma_f32_16x16x32_bf16 v[48:51], v[16:19], v[112:115], 0
    s_waitcnt lgkmcnt(3)
    v_fma_f32 v108, v108, s59, -v164
    v_fma_f32 v109, v109, s59, -v164
    v_mfma_f32_16x16x32_bf16 v[52:55], v[16:19], v[116:119], 0
    v_fma_f32 v110, v110, s59, -v164
    v_fma_f32 v111, v111, s59, -v164
    v_mfma_f32_16x16x32_bf16 v[56:59], v[16:19], v[120:123], 0
    v_exp_f32 v108, v108
    v_mfma_f32_16x16x32_bf16 v[60:63], v[16:19], v[124:127], 0
    v_exp_f32 v109, v109
    s_waitcnt lgkmcnt(2)
    v_mfma_f32_16x16x32_bf16 v[48:51], v[20:23], v[128:131], v[48:51]
    v_exp_f32 v110, v110
    v_mfma_f32_16x16x32_bf16 v[52:55], v[20:23], v[132:135], v[52:55]
    v_exp_f32 v111, v111
    v_mfma_f32_16x16x32_bf16 v[56:59], v[20:23], v[136:139], v[56:59]
    v_cvt_pk_bf16_f32 v10, v108, v109
    v_cvt_pk_bf16_f32 v11, v110, v111
    ds_write_b64 v166, v[10:11] offset:5120
    v_mfma_f32_16x16x32_bf16 v[60:63], v[20:23], v[140:143], v[60:63]
    s_waitcnt lgkmcnt(2)
    v_mfma_f32_16x16x32_bf16 v[48:51], v[24:27], v[144:147], v[48:51]
    v_mfma_f32_16x16x32_bf16 v[52:55], v[24:27], v[148:151], v[52:55]
    s_waitcnt lgkmcnt(0)
    s_barrier
    ds_read_b128 v[44:47], v14 offset:11264
    ds_read_b128 v[40:43], v14 offset:9216
    ds_read_b128 v[32:35], v14 offset:5120
    ds_read_b128 v[36:39], v14 offset:7168
    v_mfma_f32_16x16x32_bf16 v[56:59], v[24:27], v[152:155], v[56:59]
    v_mfma_f32_16x16x32_bf16 v[60:63], v[24:27], v[156:159], v[60:63]
    s_waitcnt lgkmcnt(5)
    v_mfma_f32_16x16x32_bf16 v[48:51], v[28:31], v[88:91], v[48:51]
    s_waitcnt lgkmcnt(15)
    v_mfma_f32_16x16x32_bf16 v[52:55], v[28:31], v[92:95], v[52:55]
    s_waitcnt lgkmcnt(14)
    v_mfma_f32_16x16x32_bf16 v[56:59], v[28:31], v[96:99], v[56:59]
    s_waitcnt lgkmcnt(12)
    v_mfma_f32_16x16x32_bf16 v[60:63], v[28:31], v[100:103], v[60:63]
    s_waitcnt lgkmcnt(3)
    v_mfma_f32_16x16x32_bf16 v[64:67], v[44:47], v[88:91], 0
    v_mfma_f32_16x16x32_bf16 v[68:71], v[44:47], v[92:95], 0
    v_mfma_f32_16x16x32_bf16 v[72:75], v[44:47], v[96:99], 0
    v_mfma_f32_16x16x32_bf16 v[76:79], v[44:47], v[100:103], 0
    s_waitcnt lgkmcnt(1)
    v_mfma_f32_16x16x32_bf16 v[64:67], v[32:35], v[112:115], v[64:67]
    v_mfma_f32_16x16x32_bf16 v[68:71], v[32:35], v[116:119], v[68:71]
    v_mfma_f32_16x16x32_bf16 v[72:75], v[32:35], v[120:123], v[72:75]
    v_cvt_pk_bf16_f32 v16, v48, v52
    v_cvt_pk_bf16_f32 v17, v56, v60
    v_mfma_f32_16x16x32_bf16 v[76:79], v[32:35], v[124:127], v[76:79]
    v_and_or_b32 v16, v16, -2, v4
    v_and_or_b32 v17, v17, -2, v6
    buffer_store_dwordx2 v[16:17], v12, s[48:51], s65 offen sc1
    s_add_u32 s65, s65, 132096
    s_waitcnt lgkmcnt(0)
    v_mfma_f32_16x16x32_bf16 v[64:67], v[36:39], v[128:131], v[64:67]
    v_cvt_pk_bf16_f32 v18, v49, v53
    v_cvt_pk_bf16_f32 v19, v57, v61
    v_mfma_f32_16x16x32_bf16 v[68:71], v[36:39], v[132:135], v[68:71]
    v_and_or_b32 v18, v18, -2, v4
    v_and_or_b32 v19, v19, -2, v6
    buffer_store_dwordx2 v[18:19], v12, s[48:51], s65 offen sc1
    s_add_u32 s65, s65, 132096
    v_mfma_f32_16x16x32_bf16 v[72:75], v[36:39], v[136:139], v[72:75]
    v_cvt_pk_bf16_f32 v20, v50, v54
    v_cvt_pk_bf16_f32 v21, v58, v62
    v_mfma_f32_16x16x32_bf16 v[76:79], v[36:39], v[140:143], v[76:79]
    v_and_or_b32 v20, v20, -2, v4
    v_and_or_b32 v21, v21, -2, v6
    buffer_store_dwordx2 v[20:21], v12, s[48:51], s65 offen sc1
    s_add_u32 s65, s65, 132096
    s_waitcnt lgkmcnt(2)
    v_mfma_f32_16x16x32_bf16 v[64:67], v[40:43], v[144:147], v[64:67]
    v_cvt_pk_bf16_f32 v22, v51, v55
    v_cvt_pk_bf16_f32 v23, v59, v63
    v_mfma_f32_16x16x32_bf16 v[68:71], v[40:43], v[148:151], v[68:71]
    v_and_or_b32 v22, v22, -2, v4
    v_and_or_b32 v23, v23, -2, v6
    buffer_store_dwordx2 v[22:23], v12, s[48:51], s65 offen sc1
    v_mfma_f32_16x16x32_bf16 v[72:75], v[40:43], v[152:155], v[72:75]
    v_mfma_f32_16x16x32_bf16 v[76:79], v[40:43], v[156:159], v[76:79]
    s_nop 2
    v_cvt_pk_bf16_f32 v32, v64, v68
    s_nop 3
    v_cvt_pk_bf16_f32 v33, v72, v76
    v_and_or_b32 v32, v32, -2, v4
    v_and_or_b32 v33, v33, -2, v6
    buffer_store_dwordx2 v[32:33], v12, s[48:51], s66 offen sc1
    s_add_u32 s66, s66, 132096
    v_cvt_pk_bf16_f32 v34, v65, v69
    v_cvt_pk_bf16_f32 v35, v73, v77
    v_and_or_b32 v34, v34, -2, v4
    v_and_or_b32 v35, v35, -2, v6
    buffer_store_dwordx2 v[34:35], v12, s[48:51], s66 offen sc1
    s_add_u32 s66, s66, 132096
    v_cvt_pk_bf16_f32 v36, v66, v70
    v_cvt_pk_bf16_f32 v37, v74, v78
    v_and_or_b32 v36, v36, -2, v4
    v_and_or_b32 v37, v37, -2, v6
    buffer_store_dwordx2 v[36:37], v12, s[48:51], s66 offen sc1
    s_add_u32 s66, s66, 132096
    v_cvt_pk_bf16_f32 v38, v67, v71
    v_cvt_pk_bf16_f32 v39, v75, v79
    v_and_or_b32 v38, v38, -2, v4
    v_and_or_b32 v39, v39, -2, v6
    buffer_store_dwordx2 v[38:39], v12, s[48:51], s66 offen sc1
    s_nop 0
L_K_ffn:
    s_mov_b32 s5, s57
    s_mul_i32 s62, s4, 9
    s_add_u32 s62, s62, s5
    s_add_u32 s63, s62, 32
    s_cmp_ge_u32 s5, 9
    s_cbranch_scc1 L_Z
    v_mul_u32_u24 v4, 239616, v2
    v_and_b32 v7, 3, v1
    v_lshl_add_u32 v7, v7, 4, v4
    v_and_b32 v4, 8, v1
    v_lshl_add_u32 v7, v4, 3, v7
    v_bfe_u32 v4, v1, 2, 1
    v_mul_u32_u24 v4, 13312, v4
    v_add_u32 v7, v7, v4
    s_mul_i32 s64, s3, 208
    s_add_u32 s64, s64, s63
    s_lshl_b32 s64, s64, 7
    s_add_u32 s64, s64, 1048576
    v_and_b32 v15, 7, v1
    v_lshlrev_b32 v15, 5, v15
    v_lshl_add_u32 v15, v2, 8, v15
    s_lshl_b32 s59, s3, 10
    s_add_u32 s59, s59, 8192
    v_add_u32 v15, s59, v15
    v_lshrrev_b32 v4, 3, v3
    v_lshlrev_b32 v4, 2, v4
    v_add_u32 v4, v4, v2
    v_mul_u32_u24 v4, 73728, v4
    v_and_b32 v5, 7, v3
    v_lshl_add_u32 v5, v5, 4, v4
    v_lshrrev_b32 v4, 3, v3
    v_lshlrev_b32 v4, 2, v4
    v_add_u32 v4, v4, v2
    v_mul_u32_u24 v4, 9216, v4
    v_and_b32 v6, 7, v3
    v_lshl_add_u32 v6, v6, 4, v4
    s_mul_i32 s59, s3, 589824
    s_lshl_b32 s60, s62, 7
    s_add_u32 s59, s59, s60
    s_mov_b32 s60, s59
    s_mul_i32 s65, s62, 73728
    s_lshl_b32 s66, s3, 7
    s_add_u32 s65, s65, s66
    v_lshrrev_b32 v4, 2, v3
    v_and_b32 v4, 2, v4
    v_add_u32 v4, v4, v3
    v_and_b32 v4, 3, v4
    v_mul_u32_u24 v14, 1152, v4
    v_bfe_u32 v4, v3, 2, 1
    v_mul_u32_u24 v4, 64, v4
    v_add_u32 v14, v14, v4
    v_mul_u32_u24 v4, 16, v2
    v_add_u32 v14, v14, v4
    s_lshl_b32 s66, s3, 7
    v_add_u32 v14, s66, v14
    s_barrier
    s_setprio 0
    s_cmp_lg_u32 s3, 8
    s_cbranch_scc1 L_drg
    v_lshlrev_b32 v53, 1, v1
    ds_write_b128 v52, v[64:67] offset:0
    ds_write_b16 v53, v72 offset:1024
    ds_write_b128 v52, v[76:79] offset:1152
    ds_write_b16 v53, v84 offset:2176
    ds_write_b128 v52, v[88:91] offset:2304
    ds_write_b16 v53, v96 offset:3328
    ds_write_b128 v52, v[100:103] offset:3456
    ds_write_b16 v53, v108 offset:4480
    s_waitcnt lgkmcnt(0)
L_drg:
    s_setprio 2
    buffer_load_dwordx4 v[16:19], v5, s[32:35], s59 offen
    s_add_u32 s59, s59, 9216
    buffer_load_dwordx4 v[20:23], v5, s[32:35], s59 offen
    s_add_u32 s59, s59, 9216
    buffer_load_dwordx4 v[24:27], v5, s[32:35], s59 offen
    s_add_u32 s59, s59, 9216
    buffer_load_dwordx4 v[28:31], v5, s[32:35], s59 offen
    s_add_u32 s59, s59, 9216
    s_barrier
    ds_read_b128 v[164:167], v14 offset:0
    v_lshrrev_b32 v4, 2, v3
    v_and_b32 v4, 2, v4
    v_add_u32 v4, v4, v3
    v_and_b32 v4, 3, v4
    v_mul_u32_u24 v14, 128, v4
    v_bfe_u32 v4, v3, 2, 1
    v_mul_u32_u24 v4, 64, v4
    v_add_u32 v14, v14, v4
    v_mul_u32_u24 v4, 16, v2
    v_add_u32 v14, v14, v4
    buffer_load_dwordx4 v[32:35], v5, s[32:35], s59 offen
    s_add_u32 s59, s59, 9216
    buffer_load_dwordx4 v[36:39], v5, s[32:35], s59 offen
    s_add_u32 s59, s59, 9216
    buffer_load_dwordx4 v[40:43], v5, s[32:35], s59 offen
    s_add_u32 s59, s59, 9216
    buffer_load_dwordx4 v[44:47], v5, s[32:35], s59 offen
    s_waitcnt vmcnt(7)
    s_setprio 1
    buffer_load_dwordx4 v[48:51], v5, s[36:39], s60 offen
    s_add_u32 s60, s60, 9216
    s_waitcnt vmcnt(7)
    buffer_load_dwordx4 v[52:55], v5, s[36:39], s60 offen
    s_add_u32 s60, s60, 9216
    s_waitcnt vmcnt(7)
    buffer_load_dwordx4 v[56:59], v5, s[36:39], s60 offen
    s_add_u32 s60, s60, 9216
    s_waitcnt vmcnt(7)
    buffer_load_dwordx4 v[60:63], v5, s[36:39], s60 offen
    s_add_u32 s60, s60, 9216
    s_waitcnt vmcnt(7)
    buffer_load_dwordx4 v[64:67], v5, s[36:39], s60 offen
    s_add_u32 s60, s60, 9216
    s_waitcnt vmcnt(7)
    buffer_load_dwordx4 v[68:71], v5, s[36:39], s60 offen
    s_add_u32 s60, s60, 9216
    s_waitcnt vmcnt(7)
    buffer_load_dwordx4 v[72:75], v5, s[36:39], s60 offen
    s_add_u32 s60, s60, 9216
    s_waitcnt vmcnt(7)
    buffer_load_dwordx4 v[76:79], v5, s[36:39], s60 offen
    s_waitcnt vmcnt(8) lgkmcnt(0)
    v_perm_b32 v112, v20, v16, s6
    v_perm_b32 v113, v28, v24, s6
    v_perm_b32 v114, v36, v32, s6
    v_perm_b32 v115, v44, v40, s6
    v_perm_b32 v116, v20, v16, s7
    v_perm_b32 v117, v28, v24, s7
    v_perm_b32 v118, v36, v32, s7
    v_perm_b32 v119, v44, v40, s7
    v_mfma_f32_16x16x32_bf16 v[124:127], v[164:167], v[112:115], 0
    v_perm_b32 v120, v21, v17, s6
    v_perm_b32 v121, v29, v25, s6
    v_perm_b32 v122, v37, v33, s6
    v_perm_b32 v123, v45, v41, s6
    v_mfma_f32_16x16x32_bf16 v[128:131], v[164:167], v[116:119], 0
    v_perm_b32 v112, v21, v17, s7
    v_perm_b32 v113, v29, v25, s7
    v_perm_b32 v114, v37, v33, s7
    v_perm_b32 v115, v45, v41, s7
    v_mfma_f32_16x16x32_bf16 v[132:135], v[164:167], v[120:123], 0
    v_perm_b32 v116, v22, v18, s6
    v_perm_b32 v117, v30, v26, s6
    v_perm_b32 v118, v38, v34, s6
    v_perm_b32 v119, v46, v42, s6
    v_mfma_f32_16x16x32_bf16 v[136:139], v[164:167], v[112:115], 0
    v_perm_b32 v120, v22, v18, s7
    v_perm_b32 v121, v30, v26, s7
    v_perm_b32 v122, v38, v34, s7
    v_perm_b32 v123, v46, v42, s7
    v_mfma_f32_16x16x32_bf16 v[140:143], v[164:167], v[116:119], 0
    v_perm_b32 v112, v23, v19, s6
    v_perm_b32 v113, v31, v27, s6
    v_perm_b32 v114, v39, v35, s6
    v_perm_b32 v115, v47, v43, s6
    v_mfma_f32_16x16x32_bf16 v[144:147], v[164:167], v[120:123], 0
    v_perm_b32 v116, v23, v19, s7
    v_perm_b32 v117, v31, v27, s7
    v_perm_b32 v118, v39, v35, s7
    v_perm_b32 v119, v47, v43, s7
    v_mfma_f32_16x16x32_bf16 v[148:151], v[164:167], v[112:115], 0
    s_nop 0
    v_mfma_f32_16x16x32_bf16 v[152:155], v[164:167], v[116:119], 0
    v_permlane16_swap_b32 v124, v125
    v_permlane16_swap_b32 v128, v129
    v_permlane16_swap_b32 v132, v133
    v_permlane16_swap_b32 v136, v137
    v_permlane16_swap_b32 v140, v141
    v_permlane16_swap_b32 v144, v145
    v_permlane16_swap_b32 v148, v149
    s_nop 0
    v_permlane16_swap_b32 v152, v153
    v_add_f32_dpp v156, v125, v124 row_ror:8 row_mask:0xf bank_mask:0xf
    v_add_f32_dpp v157, v129, v128 row_ror:8 row_mask:0xf bank_mask:0xf
    v_add_f32_dpp v158, v133, v132 row_ror:8 row_mask:0xf bank_mask:0xf
    v_add_f32_dpp v159, v137, v136 row_ror:8 row_mask:0xf bank_mask:0xf
    v_add_f32_dpp v160, v141, v140 row_ror:8 row_mask:0xf bank_mask:0xf
    v_add_f32_dpp v161, v145, v144 row_ror:8 row_mask:0xf bank_mask:0xf
    v_add_f32_dpp v162, v149, v148 row_ror:8 row_mask:0xf bank_mask:0xf
    v_add_f32_dpp v163, v153, v152 row_ror:8 row_mask:0xf bank_mask:0xf
    s_mov_b32 exec_lo, 0x00ff00ff
    s_mov_b32 exec_hi, 0x00ff00ff
    ds_write_b128 v15, v[156:159] offset:0
    ds_write_b128 v15, v[160:163] offset:16
    s_mov_b64 exec, -1
    s_waitcnt vmcnt(7)
    s_setprio 0
    buffer_load_dwordx4 v[80:83], v6, s[40:43], s65 offen
    s_add_u32 s65, s65, 1152
    s_waitcnt vmcnt(7)
    buffer_load_dwordx4 v[84:87], v6, s[40:43], s65 offen
    s_add_u32 s65, s65, 1152
    s_waitcnt vmcnt(7)
    buffer_load_dwordx4 v[88:91], v6, s[40:43], s65 offen
    s_add_u32 s65, s65, 1152
    s_waitcnt vmcnt(7)
    buffer_load_dwordx4 v[92:95], v6, s[40:43], s65 offen
    s_add_u32 s65, s65, 1152
    s_waitcnt vmcnt(7)
    buffer_load_dwordx4 v[96:99], v6, s[40:43], s65 offen
    s_add_u32 s65, s65, 1152
    s_waitcnt vmcnt(7)
    buffer_load_dwordx4 v[100:103], v6, s[40:43], s65 offen
    s_add_u32 s65, s65, 1152
    s_waitcnt vmcnt(7)
    buffer_load_dwordx4 v[104:107], v6, s[40:43], s65 offen
    s_add_u32 s65, s65, 1152
    s_waitcnt vmcnt(7)
    buffer_load_dwordx4 v[108:111], v6, s[40:43], s65 offen
    s_setprio 1
    s_waitcnt vmcnt(8)
    v_perm_b32 v112, v52, v48, s6
    v_perm_b32 v113, v60, v56, s6
    v_perm_b32 v114, v68, v64, s6
    v_perm_b32 v115, v76, v72, s6
    v_perm_b32 v116, v52, v48, s7
    v_perm_b32 v117, v60, v56, s7
    v_perm_b32 v118, v68, v64, s7
    v_perm_b32 v119, v76, v72, s7
    v_mfma_f32_16x16x32_bf16 v[124:127], v[164:167], v[112:115], 0
    v_perm_b32 v120, v53, v49, s6
    v_perm_b32 v121, v61, v57, s6
    v_perm_b32 v122, v69, v65, s6
    v_perm_b32 v123, v77, v73, s6
    v_mfma_f32_16x16x32_bf16 v[128:131], v[164:167], v[116:119], 0
    v_perm_b32 v112, v53, v49, s7
    v_perm_b32 v113, v61, v57, s7
    v_perm_b32 v114, v69, v65, s7
    v_perm_b32 v115, v77, v73, s7
    v_mfma_f32_16x16x32_bf16 v[132:135], v[164:167], v[120:123], 0
    v_perm_b32 v116, v54, v50, s6
    v_perm_b32 v117, v62, v58, s6
    v_perm_b32 v118, v70, v66, s6
    v_perm_b32 v119, v78, v74, s6
    v_mfma_f32_16x16x32_bf16 v[136:139], v[164:167], v[112:115], 0
    v_perm_b32 v120, v54, v50, s7
    v_perm_b32 v121, v62, v58, s7
    v_perm_b32 v122, v70, v66, s7
    v_perm_b32 v123, v78, v74, s7
    v_mfma_f32_16x16x32_bf16 v[140:143], v[164:167], v[116:119], 0
    v_perm_b32 v112, v55, v51, s6
    v_perm_b32 v113, v63, v59, s6
    v_perm_b32 v114, v71, v67, s6
    v_perm_b32 v115, v79, v75, s6
    v_mfma_f32_16x16x32_bf16 v[144:147], v[164:167], v[120:123], 0
    v_perm_b32 v116, v55, v51, s7
    v_perm_b32 v117, v63, v59, s7
    v_perm_b32 v118, v71, v67, s7
    v_perm_b32 v119, v79, v75, s7
    v_mfma_f32_16x16x32_bf16 v[148:151], v[164:167], v[112:115], 0
    s_nop 0
    v_mfma_f32_16x16x32_bf16 v[152:155], v[164:167], v[116:119], 0
    v_permlane16_swap_b32 v124, v125
    v_permlane16_swap_b32 v128, v129
    v_permlane16_swap_b32 v132, v133
    v_permlane16_swap_b32 v136, v137
    v_permlane16_swap_b32 v140, v141
    v_permlane16_swap_b32 v144, v145
    v_permlane16_swap_b32 v148, v149
    s_nop 0
    v_permlane16_swap_b32 v152, v153
    v_add_f32_dpp v156, v125, v124 row_ror:8 row_mask:0xf bank_mask:0xf
    v_add_f32_dpp v157, v129, v128 row_ror:8 row_mask:0xf bank_mask:0xf
    v_add_f32_dpp v158, v133, v132 row_ror:8 row_mask:0xf bank_mask:0xf
    v_add_f32_dpp v159, v137, v136 row_ror:8 row_mask:0xf bank_mask:0xf
    v_add_f32_dpp v160, v141, v140 row_ror:8 row_mask:0xf bank_mask:0xf
    v_add_f32_dpp v161, v145, v144 row_ror:8 row_mask:0xf bank_mask:0xf
    v_add_f32_dpp v162, v149, v148 row_ror:8 row_mask:0xf bank_mask:0xf
    v_add_f32_dpp v163, v153, v152 row_ror:8 row_mask:0xf bank_mask:0xf
    s_mov_b32 exec_lo, 0x00ff00ff
    s_mov_b32 exec_hi, 0x00ff00ff
    ds_write_b128 v15, v[156:159] offset:9216
    ds_write_b128 v15, v[160:163] offset:9232
    s_mov_b64 exec, -1
    v_lshlrev_b32 v4, 2, v0
    s_waitcnt lgkmcnt(0)
    s_barrier
    s_cmp_ge_u32 s3, 4
    s_cbranch_scc1 L_G_noact
    ds_read2st64_b32 v[124:125], v4 offset0:32 offset1:36
    ds_read2st64_b32 v[126:127], v4 offset0:40 offset1:44
    ds_read2st64_b32 v[128:129], v4 offset0:48 offset1:52
    ds_read2st64_b32 v[130:131], v4 offset0:56 offset1:60
    ds_read_b32 v132, v4 offset:16384
    ds_read2st64_b32 v[134:135], v4 offset0:68 offset1:72
    ds_read2st64_b32 v[136:137], v4 offset0:76 offset1:80
    ds_read2st64_b32 v[138:139], v4 offset0:84 offset1:88
    ds_read2st64_b32 v[140:141], v4 offset0:92 offset1:96
    ds_read_b32 v142, v4 offset:25600
    s_waitcnt lgkmcnt(5)
    v_add_f32 v124, v124, v125
    v_add_f32 v126, v126, v127
    v_add_f32 v128, v128, v129
    v_add_f32 v130, v130, v131
    v_add_f32 v124, v124, v126
    v_add_f32 v128, v128, v130
    v_add_f32 v124, v124, v128
    v_add_f32 v124, v124, v132
    v_cvt_pk_bf16_f32 v124, v124, v124
    v_and_b32 v124, 0xffff0000, v124
    v_mul_f32 v125, v124, v124
    v_mov_b32 v126, 0xc0135761
    v_fmac_f32 v126, 0xbdd2d3e8, v125
    v_mul_f32 v126, v126, v124
    v_exp_f32 v126, v126
    s_nop 0
    v_add_f32 v126, 1.0, v126
    v_rcp_f32 v126, v126
    s_nop 0
    v_mul_f32 v124, v124, v126
    v_cvt_pk_bf16_f32 v124, v124, v124
    v_and_b32 v124, 0xffff0000, v124
    s_waitcnt lgkmcnt(0)
    v_add_f32 v134, v134, v135
    v_add_f32 v136, v136, v137
    v_add_f32 v138, v138, v139
    v_add_f32 v140, v140, v141
    v_add_f32 v134, v134, v136
    v_add_f32 v138, v138, v140
    v_add_f32 v134, v134, v138
    v_add_f32 v134, v134, v142
    v_cvt_pk_bf16_f32 v134, v134, v134
    v_and_b32 v134, 0xffff0000, v134
    v_mul_f32 v124, v124, v134
    v_cvt_pk_bf16_f32 v124, v124, v124
    v_lshlrev_b32 v4, 1, v0
    ds_write_b16 v4, v124 offset:5632
    s_nop 0
L_G_noact:
    s_waitcnt vmcnt(0)
    v_perm_b32 v16, v84, v80, s6
    v_perm_b32 v17, v92, v88, s6
    v_perm_b32 v18, v100, v96, s6
    v_perm_b32 v19, v108, v104, s6
    v_perm_b32 v20, v84, v80, s7
    v_perm_b32 v21, v92, v88, s7
    v_perm_b32 v22, v100, v96, s7
    v_perm_b32 v23, v108, v104, s7
    v_perm_b32 v24, v85, v81, s6
    v_perm_b32 v25, v93, v89, s6
    v_perm_b32 v26, v101, v97, s6
    v_perm_b32 v27, v109, v105, s6
    v_perm_b32 v28, v85, v81, s7
    v_perm_b32 v29, v93, v89, s7
    v_perm_b32 v30, v101, v97, s7
    v_perm_b32 v31, v109, v105, s7
    v_perm_b32 v32, v86, v82, s6
    v_perm_b32 v33, v94, v90, s6
    v_perm_b32 v34, v102, v98, s6
    v_perm_b32 v35, v110, v106, s6
    v_perm_b32 v36, v86, v82, s7
    v_perm_b32 v37, v94, v90, s7
    v_perm_b32 v38, v102, v98, s7
    v_perm_b32 v39, v110, v106, s7
    v_perm_b32 v40, v87, v83, s6
    v_perm_b32 v41, v95, v91, s6
    v_perm_b32 v42, v103, v99, s6
    v_perm_b32 v43, v111, v107, s6
    v_perm_b32 v44, v87, v83, s7
    v_perm_b32 v45, v95, v91, s7
    v_perm_b32 v46, v103, v99, s7
    v_perm_b32 v47, v111, v107, s7
    s_waitcnt lgkmcnt(0)
    s_barrier
    ds_read_b128 v[164:167], v14 offset:5632
    s_waitcnt lgkmcnt(0)
    v_mfma_f32_16x16x32_bf16 v[124:127], v[164:167], v[16:19], 0
    v_mfma_f32_16x16x32_bf16 v[128:131], v[164:167], v[20:23], 0
    v_mfma_f32_16x16x32_bf16 v[132:135], v[164:167], v[24:27], 0
    v_mfma_f32_16x16x32_bf16 v[136:139], v[164:167], v[28:31], 0
    v_mfma_f32_16x16x32_bf16 v[140:143], v[164:167], v[32:35], 0
    v_mfma_f32_16x16x32_bf16 v[144:147], v[164:167], v[36:39], 0
    v_mfma_f32_16x16x32_bf16 v[148:151], v[164:167], v[40:43], 0
    v_mfma_f32_16x16x32_bf16 v[152:155], v[164:167], v[44:47], 0
    v_mov_b32 v161, s54
    v_mov_b32 v163, s54
    v_permlane16_swap_b32 v124, v125
    v_permlane16_swap_b32 v128, v129
    v_permlane16_swap_b32 v132, v133
    v_permlane16_swap_b32 v136, v137
    v_permlane16_swap_b32 v140, v141
    v_permlane16_swap_b32 v144, v145
    v_permlane16_swap_b32 v148, v149
    v_permlane16_swap_b32 v152, v153
    v_add_f32_dpp v156, v125, v124 row_ror:8 row_mask:0xf bank_mask:0x3
    v_add_f32_dpp v157, v129, v128 row_ror:8 row_mask:0xf bank_mask:0x3
    v_add_f32_dpp v158, v133, v132 row_ror:8 row_mask:0xf bank_mask:0x3
    v_add_f32_dpp v159, v137, v136 row_ror:8 row_mask:0xf bank_mask:0x3
    v_add_f32_dpp v156, v140, v141 row_ror:8 row_mask:0xf bank_mask:0xc
    v_add_f32_dpp v157, v144, v145 row_ror:8 row_mask:0xf bank_mask:0xc
    v_add_f32_dpp v158, v148, v149 row_ror:8 row_mask:0xf bank_mask:0xc
    v_add_f32_dpp v159, v152, v153 row_ror:8 row_mask:0xf bank_mask:0xc
    v_cvt_pk_bf16_f32 v160, v156, v157
    v_cvt_pk_bf16_f32 v162, v158, v159
    buffer_store_dwordx4 v[160:163], v7, s[48:51], s64 offen sc1
    v_and_b32 v8, 3, v1
    v_lshlrev_b32 v8, 3, v8
    v_add_u32 v8, v8, v2
    v_and_b32 v4, 4, v1
    v_add_u32 v8, v8, v4
    v_lshlrev_b32 v5, 1, v8
    s_lshl_b32 s63, s62, 6
    buffer_load_ushort v60, v5, s[8:11], s63 offen
    s_mul_i32 s59, s62, 13312
    s_add_u32 s59, s59, 1048576
    s_lshl_b32 s60, s3, 10
    s_add_u32 s61, s59, s60
    s_add_u32 s61, s61, 4096
    v_lshlrev_b32 v6, 4, v1
    v_lshlrev_b32 v8, 2, v8
    s_lshl_b32 s60, s3, 7
    v_add_u32 v7, s60, v8
    s_waitcnt vmcnt(0)
    s_mov_b64 vcc, -1
    s_mov_b32 s55, 0
L_F_y:
    s_mov_b64 exec, vcc
    buffer_load_dwordx4 v[32:35], v6, s[48:51], s61 offen sc1
    s_mov_b64 exec, -1
    s_waitcnt vmcnt(0)
    v_xor_b32 v52, s54, v33
    v_xor_b32 v53, s54, v35
    v_or_b32 v52, v52, v53
    v_cmp_ne_u32 vcc, 0, v52
    s_nop 0
    s_cbranch_vccz L_sd_7
    s_add_u32 s55, s55, 1
    s_cmp_lt_u32 s55, 524288
    s_cbranch_scc1 L_F_y
L_sd_7:
    s_cmp_lg_u32 s3, 0
    s_cbranch_scc1 L_F_ns
    buffer_load_dwordx4 v[16:19], v6, s[48:51], s59 offen offset:0 sc1
    buffer_load_dwordx4 v[20:23], v6, s[48:51], s59 offen offset:1024 sc1
    buffer_load_dwordx4 v[24:27], v6, s[48:51], s59 offen offset:2048 sc1
    buffer_load_dwordx4 v[28:31], v6, s[48:51], s59 offen offset:3072 sc1
L_F_ns:
    v_lshlrev_b32 v40, 16, v32
    v_and_b32 v41, 0xffff0000, v32
    v_lshlrev_b32 v42, 16, v34
    v_and_b32 v43, 0xffff0000, v34
    v_add_f32_dpp v40, v40, v40 row_ror:8 row_mask:0xf bank_mask:0xf
    v_add_f32_dpp v41, v41, v41 row_ror:8 row_mask:0xf bank_mask:0xf
    v_add_f32_dpp v42, v42, v42 row_ror:8 row_mask:0xf bank_mask:0xf
    v_add_f32_dpp v43, v43, v43 row_ror:8 row_mask:0xf bank_mask:0xf
    s_nop 0
    v_permlane32_swap_b32 v40, v42
    v_permlane32_swap_b32 v41, v43
    v_add_f32 v40, v40, v42
    v_add_f32 v41, v41, v43
    s_nop 1
    v_permlane16_swap_b32 v40, v41
    v_add_f32 v40, v40, v41
    ds_write_b32 v7, v40 offset:28672
    s_waitcnt lgkmcnt(0)
    s_barrier
    s_cmp_lg_u32 s3, 0
    s_cbranch_scc1 L_fin
    ds_read_b32 v40, v8 offset:28672
    ds_read_b32 v41, v8 offset:28800
    ds_read_b32 v42, v8 offset:28928
    ds_read_b32 v43, v8 offset:29056
    ds_read_b32 v44, v8 offset:29184
    ds_read_b32 v45, v8 offset:29312
    ds_read_b32 v46, v8 offset:29440
    ds_read_b32 v47, v8 offset:29568
    ds_read_b32 v48, v8 offset:29696
    v_lshlrev_b32 v60, 16, v60
    s_mov_b32 s55, 0
    s_waitcnt lgkmcnt(0)
    v_add_f32 v40, v40, v41
    v_add_f32 v42, v42, v43
    v_add_f32 v44, v44, v45
    v_add_f32 v46, v46, v47
    v_add_f32 v40, v40, v42
    v_add_f32 v44, v44, v46
    v_add_f32 v40, v40, v44
    v_add_f32 v40, v40, v48
    v_cvt_pk_bf16_f32 v40, v40, v40
    v_and_b32 v40, 0xffff0000, v40
    v_mul_f32 v41, 0xbfb8aa3b, v40
    v_exp_f32 v41, v41
    s_nop 0
    v_add_f32 v41, 1.0, v41
    v_rcp_f32 v41, v41
    s_nop 0
    v_mul_f32 v40, v40, v41
    v_cvt_pk_bf16_f32 v40, v40, v40
    v_and_b32 v40, 0xffff0000, v40
    s_nop 0
    s_branch L_F_sc
L_F_s:
    s_mov_b64 exec, vcc
    buffer_load_dwordx4 v[16:19], v6, s[48:51], s59 offen offset:0 sc1
    buffer_load_dwordx4 v[20:23], v6, s[48:51], s59 offen offset:1024 sc1
    buffer_load_dwordx4 v[24:27], v6, s[48:51], s59 offen offset:2048 sc1
    buffer_load_dwordx4 v[28:31], v6, s[48:51], s59 offen offset:3072 sc1
    s_mov_b64 exec, -1
L_F_sc:
    s_waitcnt vmcnt(0)
    v_min3_u32 v52, v17, v19, s54
    v_max3_u32 v53, v17, v19, s54
    v_min3_u32 v52, v52, v21, v23
    v_max3_u32 v53, v53, v21, v23
    v_min3_u32 v52, v52, v25, v27
    v_max3_u32 v53, v53, v25, v27
    v_min3_u32 v52, v52, v29, v31
    v_max3_u32 v53, v53, v29, v31
    v_cmp_ne_u32 vcc, v52, v53
    s_nop 0
    s_cbranch_vccz L_sd_8
    s_add_u32 s55, s55, 1
    s_cmp_lt_u32 s55, 524288
    s_cbranch_scc1 L_F_s
L_sd_8:
    v_lshlrev_b32 v64, 16, v16
    v_and_b32 v65, 0xffff0000, v16
    v_lshlrev_b32 v66, 16, v18
    v_and_b32 v67, 0xffff0000, v18
    v_lshlrev_b32 v68, 16, v20
    v_and_b32 v69, 0xffff0000, v20
    v_lshlrev_b32 v70, 16, v22
    v_and_b32 v71, 0xffff0000, v22
    v_lshlrev_b32 v72, 16, v24
    v_and_b32 v73, 0xffff0000, v24
    v_lshlrev_b32 v74, 16, v26
    v_and_b32 v75, 0xffff0000, v26
    v_lshlrev_b32 v76, 16, v28
    v_and_b32 v77, 0xffff0000, v28
    v_lshlrev_b32 v78, 16, v30
    v_and_b32 v79, 0xffff0000, v30
    v_add_f32 v64, v64, v68
    v_add_f32 v72, v72, v76
    v_add_f32 v65, v65, v69
    v_add_f32 v73, v73, v77
    v_add_f32 v66, v66, v70
    v_add_f32 v74, v74, v78
    v_add_f32 v67, v67, v71
    v_add_f32 v75, v75, v79
    v_add_f32 v64, v64, v72
    v_add_f32 v65, v65, v73
    v_add_f32 v66, v66, v74
    v_add_f32 v67, v67, v75
    v_add_f32_dpp v64, v64, v64 row_ror:8 row_mask:0xf bank_mask:0xf
    v_add_f32_dpp v65, v65, v65 row_ror:8 row_mask:0xf bank_mask:0xf
    v_add_f32_dpp v66, v66, v66 row_ror:8 row_mask:0xf bank_mask:0xf
    v_add_f32_dpp v67, v67, v67 row_ror:8 row_mask:0xf bank_mask:0xf
    s_nop 0
    v_permlane32_swap_b32 v64, v66
    v_permlane32_swap_b32 v65, v67
    v_add_f32 v64, v64, v66
    v_add_f32 v65, v65, v67
    s_nop 1
    v_permlane16_swap_b32 v64, v65
    v_add_f32 v64, v64, v65
    v_cvt_pk_bf16_f32 v64, v64, v64
    v_and_b32 v64, 0xffff0000, v64
    v_mul_f32 v64, v64, v40
    v_cvt_pk_bf16_f32 v64, v64, v64
    v_and_b32 v64, 0xffff0000, v64
    v_add_f32 v64, v64, v60
    v_cvt_pk_bf16_f32 v64, v64, v64
    s_mov_b32 exec_lo, 0x00ff00ff
    s_mov_b32 exec_hi, 0x00ff00ff
    buffer_store_short v64, v5, s[44:47], s63 offen
    s_mov_b64 exec, -1
L_fin:
    s_endpgm
L_Z:
    s_barrier
    s_setprio 0
    s_sub_u32 s59, s5, 9
    s_mul_i32 s61, s3, 7
    s_add_u32 s59, s59, s61
    s_sub_u32 s59, 242, s59
    s_cmp_ge_u32 s59, 162
    s_cbranch_scc1 L_ft_dz
    s_cmp_ge_u32 s59, 81
    s_cselect_b32 s60, 81, 0
    s_sub_u32 s60, s59, s60
    s_lshl_b32 s60, s60, 6
    v_add_u32 v8, s60, v1
    v_mul_u32_u24 v9, 7282, v8
    v_lshrrev_b32 v9, 16, v9
    v_mul_u32_u24 v9, 63, v9
    v_add_u32 v8, v8, v9
    v_lshlrev_b32 v8, 7, v8
    s_mul_i32 s60, s4, 1152
    s_cmp_ge_u32 s59, 81
    s_cbranch_scc1 L_ft_uz
    buffer_load_dword v16, v8, s[32:35], s60 offen
    s_branch L_ft_ez
L_ft_uz:
    buffer_load_dword v16, v8, s[36:39], s60 offen
    s_branch L_ft_ez
L_ft_dz:
    v_lshlrev_b32 v8, 7, v1
    s_mul_i32 s60, s4, 81
    s_add_u32 s60, s60, s59
    s_sub_u32 s60, s60, 162
    s_lshl_b32 s60, s60, 13
    s_cmp_ge_u32 s59, 243
    s_cselect_b32 s60, 5308416, s60
    buffer_load_dword v16, v8, s[40:43], s60 offen
L_ft_ez:
    s_waitcnt vmcnt(0)
    s_endpgm
L_K8:
    s_setprio 2
    v_lshlrev_b32 v6, 1, v1
    buffer_load_dwordx4 v[68:71], v5, s[8:11], 0 offen offset:0
    buffer_load_ushort v72, v6, s[8:11], 0 offen offset:1024
    buffer_load_dwordx4 v[80:83], v5, s[8:11], 0 offen offset:1152
    buffer_load_ushort v84, v6, s[8:11], 0 offen offset:2176
    buffer_load_dwordx4 v[92:95], v5, s[8:11], 0 offen offset:2304
    buffer_load_ushort v96, v6, s[8:11], 0 offen offset:3328
    buffer_load_dwordx4 v[104:107], v5, s[8:11], 0 offen offset:3456
    s_movk_i32 s59, 1024
    buffer_load_ushort v108, v6, s[8:11], s59 offen offset:3456
    s_load_dwordx4 s[24:27], s[0:1], 32
    s_load_dwordx8 s[36:43], s[0:1], 56
    s_load_dword s54, s[48:49], 0
    s_mov_b32 s6, 0x05040100
    s_mov_b32 s7, 0x07060302
    s_waitcnt lgkmcnt(0)
    s_mov_b64 s[28:29], s[26:27]
    s_mov_b64 s[32:33], s[36:37]
    s_mov_b64 s[36:37], s[38:39]
    s_mov_b64 s[44:45], s[42:43]
    s_mov_b32 s26, 4194304
    s_mov_b32 s27, 0x20000
    s_mov_b32 s30, 4718592
    s_mov_b32 s31, 0x20000
    s_mov_b32 s34, 5308416
    s_mov_b32 s35, 0x20000
    s_mov_b32 s38, 5308416
    s_mov_b32 s39, 0x20000
    s_mov_b32 s42, 5308416
    s_mov_b32 s43, 0x20000
    s_mov_b32 s46, 4608
    s_mov_b32 s47, 0x20000
    s_lshl_b32 s59, s58, 9
    s_add_u32 s59, s59, 851968
    s_mov_b32 exec_hi, 0
    buffer_load_dword v17, v5, s[48:51], s59 offen
    s_mov_b64 exec, -1
    s_waitcnt vmcnt(0) lgkmcnt(0)
    s_mul_i32 s54, s54, 1664525
    s_add_u32 s54, s54, 1013904223
    v_lshlrev_b32 v64, 16, v68
    v_and_b32 v65, 0xffff0000, v68
    v_lshlrev_b32 v66, 16, v69
    v_and_b32 v67, 0xffff0000, v69
    v_lshlrev_b32 v68, 16, v70
    v_and_b32 v69, 0xffff0000, v70
    v_lshlrev_b32 v70, 16, v71
    v_and_b32 v71, 0xffff0000, v71
    v_lshlrev_b32 v72, 16, v72
    v_add_f32 v120, v64, v65
    v_add_f32 v120, v120, v66
    v_add_f32 v120, v120, v67
    v_add_f32 v120, v120, v68
    v_add_f32 v120, v120, v69
    v_add_f32 v120, v120, v70
    v_add_f32 v120, v120, v71
    v_add_f32 v120, v120, v72
    s_nop 1
    v_add_f32_dpp v120, v120, v120 row_ror:8 row_mask:0xf bank_mask:0xf
    s_nop 1
    v_add_f32_dpp v120, v120, v120 row_ror:4 row_mask:0xf bank_mask:0xf
    s_nop 1
    v_add_f32_dpp v120, v120, v120 row_ror:2 row_mask:0xf bank_mask:0xf
    s_nop 1
    v_add_f32_dpp v120, v120, v120 row_ror:1 row_mask:0xf bank_mask:0xf
    v_mov_b32 v121, v120
    s_nop 1
    v_permlane16_swap_b32 v120, v121
    v_add_f32 v120, v120, v121
    v_mov_b32 v121, v120
    s_nop 1
    v_permlane32_swap_b32 v120, v121
    v_add_f32 v120, v120, v121
    v_mul_f32 v120, 0x3ae38e39, v120
    v_sub_f32 v122, v64, v120
    v_mul_f32 v121, v122, v122
    v_sub_f32 v122, v65, v120
    v_fmac_f32 v121, v122, v122
    v_sub_f32 v122, v66, v120
    v_fmac_f32 v121, v122, v122
    v_sub_f32 v122, v67, v120
    v_fmac_f32 v121, v122, v122
    v_sub_f32 v122, v68, v120
    v_fmac_f32 v121, v122, v122
    v_sub_f32 v122, v69, v120
    v_fmac_f32 v121, v122, v122
    v_sub_f32 v122, v70, v120
    v_fmac_f32 v121, v122, v122
    v_sub_f32 v122, v71, v120
    v_fmac_f32 v121, v122, v122
    v_sub_f32 v122, v72, v120
    v_fmac_f32 v121, v122, v122
    v_cvt_pk_bf16_f32 v120, v120, v120
    v_and_b32 v120, 0xffff0000, v120
    v_add_f32_dpp v121, v121, v121 row_ror:8 row_mask:0xf bank_mask:0xf
    v_sub_f32 v64, v64, v120
    v_sub_f32 v65, v65, v120
    v_add_f32_dpp v121, v121, v121 row_ror:4 row_mask:0xf bank_mask:0xf
    v_sub_f32 v66, v66, v120
    v_sub_f32 v67, v67, v120
    v_add_f32_dpp v121, v121, v121 row_ror:2 row_mask:0xf bank_mask:0xf
    v_sub_f32 v68, v68, v120
    v_sub_f32 v69, v69, v120
    v_add_f32_dpp v121, v121, v121 row_ror:1 row_mask:0xf bank_mask:0xf
    v_sub_f32 v70, v70, v120
    v_sub_f32 v71, v71, v120
    v_sub_f32 v72, v72, v120
    v_mov_b32 v122, v121
    s_nop 1
    v_permlane16_swap_b32 v121, v122
    v_add_f32 v121, v121, v122
    v_mov_b32 v122, v121
    s_nop 1
    v_permlane32_swap_b32 v121, v122
    v_add_f32 v121, v121, v122
    v_mul_f32 v121, 0x3ae38e39, v121
    v_cvt_pk_bf16_f32 v121, v121, v121
    v_and_b32 v121, 0xffff0000, v121
    v_add_f32 v121, 0x3727c5ac, v121
    v_cvt_pk_bf16_f32 v121, v121, v121
    v_and_b32 v121, 0xffff0000, v121
    v_sqrt_f32 v121, v121
    s_nop 0
    v_cvt_pk_bf16_f32 v121, v121, v121
    v_and_b32 v121, 0xffff0000, v121
    v_rcp_f32 v121, v121
    v_cvt_pk_bf16_f32 v64, v64, v65
    v_and_b32 v65, 0xffff0000, v64
    v_lshlrev_b32 v64, 16, v64
    v_cvt_pk_bf16_f32 v66, v66, v67
    v_and_b32 v67, 0xffff0000, v66
    v_lshlrev_b32 v66, 16, v66
    v_cvt_pk_bf16_f32 v68, v68, v69
    v_and_b32 v69, 0xffff0000, v68
    v_lshlrev_b32 v68, 16, v68
    v_cvt_pk_bf16_f32 v70, v70, v71
    v_and_b32 v71, 0xffff0000, v70
    v_lshlrev_b32 v70, 16, v70
    v_cvt_pk_bf16_f32 v72, v72, v72
    v_lshlrev_b32 v72, 16, v72
    v_mul_f32 v64, v64, v121
    v_mul_f32 v65, v65, v121
    v_mul_f32 v66, v66, v121
    v_mul_f32 v67, v67, v121
    v_mul_f32 v68, v68, v121
    v_mul_f32 v69, v69, v121
    v_mul_f32 v70, v70, v121
    v_mul_f32 v71, v71, v121
    v_mul_f32 v72, v72, v121
    v_cvt_pk_bf16_f32 v64, v64, v65
    v_cvt_pk_bf16_f32 v65, v66, v67
    v_cvt_pk_bf16_f32 v66, v68, v69
    v_cvt_pk_bf16_f32 v67, v70, v71
    v_cvt_pk_bf16_f32 v72, v72, v72
    v_lshlrev_b32 v76, 16, v80
    v_and_b32 v77, 0xffff0000, v80
    v_lshlrev_b32 v78, 16, v81
    v_and_b32 v79, 0xffff0000, v81
    v_lshlrev_b32 v80, 16, v82
    v_and_b32 v81, 0xffff0000, v82
    v_lshlrev_b32 v82, 16, v83
    v_and_b32 v83, 0xffff0000, v83
    v_lshlrev_b32 v84, 16, v84
    v_add_f32 v120, v76, v77
    v_add_f32 v120, v120, v78
    v_add_f32 v120, v120, v79
    v_add_f32 v120, v120, v80
    v_add_f32 v120, v120, v81
    v_add_f32 v120, v120, v82
    v_add_f32 v120, v120, v83
    v_add_f32 v120, v120, v84
    s_nop 1
    v_add_f32_dpp v120, v120, v120 row_ror:8 row_mask:0xf bank_mask:0xf
    s_nop 1
    v_add_f32_dpp v120, v120, v120 row_ror:4 row_mask:0xf bank_mask:0xf
    s_nop 1
    v_add_f32_dpp v120, v120, v120 row_ror:2 row_mask:0xf bank_mask:0xf
    s_nop 1
    v_add_f32_dpp v120, v120, v120 row_ror:1 row_mask:0xf bank_mask:0xf
    v_mov_b32 v121, v120
    s_nop 1
    v_permlane16_swap_b32 v120, v121
    v_add_f32 v120, v120, v121
    v_mov_b32 v121, v120
    s_nop 1
    v_permlane32_swap_b32 v120, v121
    v_add_f32 v120, v120, v121
    v_mul_f32 v120, 0x3ae38e39, v120
    v_sub_f32 v122, v76, v120
    v_mul_f32 v121, v122, v122
    v_sub_f32 v122, v77, v120
    v_fmac_f32 v121, v122, v122
    v_sub_f32 v122, v78, v120
    v_fmac_f32 v121, v122, v122
    v_sub_f32 v122, v79, v120
    v_fmac_f32 v121, v122, v122
    v_sub_f32 v122, v80, v120
    v_fmac_f32 v121, v122, v122
    v_sub_f32 v122, v81, v120
    v_fmac_f32 v121, v122, v122
    v_sub_f32 v122, v82, v120
    v_fmac_f32 v121, v122, v122
    v_sub_f32 v122, v83, v120
    v_fmac_f32 v121, v122, v122
    v_sub_f32 v122, v84, v120
    v_fmac_f32 v121, v122, v122
    v_cvt_pk_bf16_f32 v120, v120, v120
    v_and_b32 v120, 0xffff0000, v120
    v_add_f32_dpp v121, v121, v121 row_ror:8 row_mask:0xf bank_mask:0xf
    v_sub_f32 v76, v76, v120
    v_sub_f32 v77, v77, v120
    v_add_f32_dpp v121, v121, v121 row_ror:4 row_mask:0xf bank_mask:0xf
    v_sub_f32 v78, v78, v120
    v_sub_f32 v79, v79, v120
    v_add_f32_dpp v121, v121, v121 row_ror:2 row_mask:0xf bank_mask:0xf
    v_sub_f32 v80, v80, v120
    v_sub_f32 v81, v81, v120
    v_add_f32_dpp v121, v121, v121 row_ror:1 row_mask:0xf bank_mask:0xf
    v_sub_f32 v82, v82, v120
    v_sub_f32 v83, v83, v120
    v_sub_f32 v84, v84, v120
    v_mov_b32 v122, v121
    s_nop 1
    v_permlane16_swap_b32 v121, v122
    v_add_f32 v121, v121, v122
    v_mov_b32 v122, v121
    s_nop 1
    v_permlane32_swap_b32 v121, v122
    v_add_f32 v121, v121, v122
    v_mul_f32 v121, 0x3ae38e39, v121
    v_cvt_pk_bf16_f32 v121, v121, v121
    v_and_b32 v121, 0xffff0000, v121
    v_add_f32 v121, 0x3727c5ac, v121
    v_cvt_pk_bf16_f32 v121, v121, v121
    v_and_b32 v121, 0xffff0000, v121
    v_sqrt_f32 v121, v121
    s_nop 0
    v_cvt_pk_bf16_f32 v121, v121, v121
    v_and_b32 v121, 0xffff0000, v121
    v_rcp_f32 v121, v121
    v_cvt_pk_bf16_f32 v76, v76, v77
    v_and_b32 v77, 0xffff0000, v76
    v_lshlrev_b32 v76, 16, v76
    v_cvt_pk_bf16_f32 v78, v78, v79
    v_and_b32 v79, 0xffff0000, v78
    v_lshlrev_b32 v78, 16, v78
    v_cvt_pk_bf16_f32 v80, v80, v81
    v_and_b32 v81, 0xffff0000, v80
    v_lshlrev_b32 v80, 16, v80
    v_cvt_pk_bf16_f32 v82, v82, v83
    v_and_b32 v83, 0xffff0000, v82
    v_lshlrev_b32 v82, 16, v82
    v_cvt_pk_bf16_f32 v84, v84, v84
    v_lshlrev_b32 v84, 16, v84
    v_mul_f32 v76, v76, v121
    v_mul_f32 v77, v77, v121
    v_mul_f32 v78, v78, v121
    v_mul_f32 v79, v79, v121
    v_mul_f32 v80, v80, v121
    v_mul_f32 v81, v81, v121
    v_mul_f32 v82, v82, v121
    v_mul_f32 v83, v83, v121
    v_mul_f32 v84, v84, v121
    v_cvt_pk_bf16_f32 v76, v76, v77
    v_cvt_pk_bf16_f32 v77, v78, v79
    v_cvt_pk_bf16_f32 v78, v80, v81
    v_cvt_pk_bf16_f32 v79, v82, v83
    v_cvt_pk_bf16_f32 v84, v84, v84
    v_and_b32 v6, 31, v1
    v_lshlrev_b32 v6, 2, v6
    s_barrier
    v_lshlrev_b32 v88, 16, v92
    v_and_b32 v89, 0xffff0000, v92
    v_lshlrev_b32 v90, 16, v93
    v_and_b32 v91, 0xffff0000, v93
    v_lshlrev_b32 v92, 16, v94
    v_and_b32 v93, 0xffff0000, v94
    v_lshlrev_b32 v94, 16, v95
    v_and_b32 v95, 0xffff0000, v95
    v_lshlrev_b32 v96, 16, v96
    v_add_f32 v120, v88, v89
    v_add_f32 v120, v120, v90
    v_add_f32 v120, v120, v91
    v_add_f32 v120, v120, v92
    v_add_f32 v120, v120, v93
    v_add_f32 v120, v120, v94
    v_add_f32 v120, v120, v95
    v_add_f32 v120, v120, v96
    s_nop 1
    v_add_f32_dpp v120, v120, v120 row_ror:8 row_mask:0xf bank_mask:0xf
    s_nop 1
    v_add_f32_dpp v120, v120, v120 row_ror:4 row_mask:0xf bank_mask:0xf
    s_nop 1
    v_add_f32_dpp v120, v120, v120 row_ror:2 row_mask:0xf bank_mask:0xf
    s_nop 1
    v_add_f32_dpp v120, v120, v120 row_ror:1 row_mask:0xf bank_mask:0xf
    v_mov_b32 v121, v120
    s_nop 1
    v_permlane16_swap_b32 v120, v121
    v_add_f32 v120, v120, v121
    v_mov_b32 v121, v120
    s_nop 1
    v_permlane32_swap_b32 v120, v121
    v_add_f32 v120, v120, v121
    v_mul_f32 v120, 0x3ae38e39, v120
    v_sub_f32 v122, v88, v120
    v_mul_f32 v121, v122, v122
    v_sub_f32 v122, v89, v120
    v_fmac_f32 v121, v122, v122
    v_sub_f32 v122, v90, v120
    v_fmac_f32 v121, v122, v122
    v_sub_f32 v122, v91, v120
    v_fmac_f32 v121, v122, v122
    v_sub_f32 v122, v92, v120
    v_fmac_f32 v121, v122, v122
    v_sub_f32 v122, v93, v120
    v_fmac_f32 v121, v122, v122
    v_sub_f32 v122, v94, v120
    v_fmac_f32 v121, v122, v122
    v_sub_f32 v122, v95, v120
    v_fmac_f32 v121, v122, v122
    v_sub_f32 v122, v96, v120
    v_fmac_f32 v121, v122, v122
    v_cvt_pk_bf16_f32 v120, v120, v120
    v_and_b32 v120, 0xffff0000, v120
    v_add_f32_dpp v121, v121, v121 row_ror:8 row_mask:0xf bank_mask:0xf
    v_sub_f32 v88, v88, v120
    v_sub_f32 v89, v89, v120
    v_add_f32_dpp v121, v121, v121 row_ror:4 row_mask:0xf bank_mask:0xf
    v_sub_f32 v90, v90, v120
    v_sub_f32 v91, v91, v120
    v_add_f32_dpp v121, v121, v121 row_ror:2 row_mask:0xf bank_mask:0xf
    v_sub_f32 v92, v92, v120
    v_sub_f32 v93, v93, v120
    v_add_f32_dpp v121, v121, v121 row_ror:1 row_mask:0xf bank_mask:0xf
    v_sub_f32 v94, v94, v120
    v_sub_f32 v95, v95, v120
    v_sub_f32 v96, v96, v120
    v_mov_b32 v122, v121
    s_nop 1
    v_permlane16_swap_b32 v121, v122
    v_add_f32 v121, v121, v122
    v_mov_b32 v122, v121
    s_nop 1
    v_permlane32_swap_b32 v121, v122
    v_add_f32 v121, v121, v122
    v_mul_f32 v121, 0x3ae38e39, v121
    v_cvt_pk_bf16_f32 v121, v121, v121
    v_and_b32 v121, 0xffff0000, v121
    v_add_f32 v121, 0x3727c5ac, v121
    v_cvt_pk_bf16_f32 v121, v121, v121
    v_and_b32 v121, 0xffff0000, v121
    v_sqrt_f32 v121, v121
    s_nop 0
    v_cvt_pk_bf16_f32 v121, v121, v121
    v_and_b32 v121, 0xffff0000, v121
    v_rcp_f32 v121, v121
    v_cvt_pk_bf16_f32 v88, v88, v89
    v_and_b32 v89, 0xffff0000, v88
    v_lshlrev_b32 v88, 16, v88
    v_cvt_pk_bf16_f32 v90, v90, v91
    v_and_b32 v91, 0xffff0000, v90
    v_lshlrev_b32 v90, 16, v90
    v_cvt_pk_bf16_f32 v92, v92, v93
    v_and_b32 v93, 0xffff0000, v92
    v_lshlrev_b32 v92, 16, v92
    v_cvt_pk_bf16_f32 v94, v94, v95
    v_and_b32 v95, 0xffff0000, v94
    v_lshlrev_b32 v94, 16, v94
    v_cvt_pk_bf16_f32 v96, v96, v96
    v_lshlrev_b32 v96, 16, v96
    v_mul_f32 v88, v88, v121
    v_mul_f32 v89, v89, v121
    v_mul_f32 v90, v90, v121
    v_mul_f32 v91, v91, v121
    v_mul_f32 v92, v92, v121
    v_mul_f32 v93, v93, v121
    v_mul_f32 v94, v94, v121
    v_mul_f32 v95, v95, v121
    v_mul_f32 v96, v96, v121
    v_cvt_pk_bf16_f32 v88, v88, v89
    v_cvt_pk_bf16_f32 v89, v90, v91
    v_cvt_pk_bf16_f32 v90, v92, v93
    v_cvt_pk_bf16_f32 v91, v94, v95
    v_cvt_pk_bf16_f32 v96, v96, v96
    s_barrier
    v_mov_b32 v16, 0xff800000
    ds_write_b32 v6, v16
    v_lshlrev_b32 v100, 16, v104
    v_and_b32 v101, 0xffff0000, v104
    v_lshlrev_b32 v102, 16, v105
    v_and_b32 v103, 0xffff0000, v105
    v_lshlrev_b32 v104, 16, v106
    v_and_b32 v105, 0xffff0000, v106
    v_lshlrev_b32 v106, 16, v107
    v_and_b32 v107, 0xffff0000, v107
    v_lshlrev_b32 v108, 16, v108
    v_add_f32 v120, v100, v101
    v_add_f32 v120, v120, v102
    v_add_f32 v120, v120, v103
    v_add_f32 v120, v120, v104
    v_add_f32 v120, v120, v105
    v_add_f32 v120, v120, v106
    v_add_f32 v120, v120, v107
    v_add_f32 v120, v120, v108
    s_nop 1
    v_add_f32_dpp v120, v120, v120 row_ror:8 row_mask:0xf bank_mask:0xf
    s_nop 1
    v_add_f32_dpp v120, v120, v120 row_ror:4 row_mask:0xf bank_mask:0xf
    s_nop 1
    v_add_f32_dpp v120, v120, v120 row_ror:2 row_mask:0xf bank_mask:0xf
    s_nop 1
    v_add_f32_dpp v120, v120, v120 row_ror:1 row_mask:0xf bank_mask:0xf
    v_mov_b32 v121, v120
    s_nop 1
    v_permlane16_swap_b32 v120, v121
    v_add_f32 v120, v120, v121
    v_mov_b32 v121, v120
    s_nop 1
    v_permlane32_swap_b32 v120, v121
    v_add_f32 v120, v120, v121
    v_mul_f32 v120, 0x3ae38e39, v120
    v_sub_f32 v122, v100, v120
    v_mul_f32 v121, v122, v122
    v_sub_f32 v122, v101, v120
    v_fmac_f32 v121, v122, v122
    v_sub_f32 v122, v102, v120
    v_fmac_f32 v121, v122, v122
    v_sub_f32 v122, v103, v120
    v_fmac_f32 v121, v122, v122
    v_sub_f32 v122, v104, v120
    v_fmac_f32 v121, v122, v122
    v_sub_f32 v122, v105, v120
    v_fmac_f32 v121, v122, v122
    v_sub_f32 v122, v106, v120
    v_fmac_f32 v121, v122, v122
    v_sub_f32 v122, v107, v120
    v_fmac_f32 v121, v122, v122
    v_sub_f32 v122, v108, v120
    v_fmac_f32 v121, v122, v122
    v_cvt_pk_bf16_f32 v120, v120, v120
    v_and_b32 v120, 0xffff0000, v120
    v_add_f32_dpp v121, v121, v121 row_ror:8 row_mask:0xf bank_mask:0xf
    v_sub_f32 v100, v100, v120
    v_sub_f32 v101, v101, v120
    v_add_f32_dpp v121, v121, v121 row_ror:4 row_mask:0xf bank_mask:0xf
    v_sub_f32 v102, v102, v120
    v_sub_f32 v103, v103, v120
    v_add_f32_dpp v121, v121, v121 row_ror:2 row_mask:0xf bank_mask:0xf
    v_sub_f32 v104, v104, v120
    v_sub_f32 v105, v105, v120
    v_add_f32_dpp v121, v121, v121 row_ror:1 row_mask:0xf bank_mask:0xf
    v_sub_f32 v106, v106, v120
    v_sub_f32 v107, v107, v120
    v_sub_f32 v108, v108, v120
    v_mov_b32 v122, v121
    s_nop 1
    v_permlane16_swap_b32 v121, v122
    v_add_f32 v121, v121, v122
    v_mov_b32 v122, v121
    s_nop 1
    v_permlane32_swap_b32 v121, v122
    v_add_f32 v121, v121, v122
    v_mul_f32 v121, 0x3ae38e39, v121
    v_cvt_pk_bf16_f32 v121, v121, v121
    v_and_b32 v121, 0xffff0000, v121
    v_add_f32 v121, 0x3727c5ac, v121
    v_cvt_pk_bf16_f32 v121, v121, v121
    v_and_b32 v121, 0xffff0000, v121
    v_sqrt_f32 v121, v121
    s_nop 0
    v_cvt_pk_bf16_f32 v121, v121, v121
    v_and_b32 v121, 0xffff0000, v121
    v_rcp_f32 v121, v121
    v_cvt_pk_bf16_f32 v100, v100, v101
    v_and_b32 v101, 0xffff0000, v100
    v_lshlrev_b32 v100, 16, v100
    v_cvt_pk_bf16_f32 v102, v102, v103
    v_and_b32 v103, 0xffff0000, v102
    v_lshlrev_b32 v102, 16, v102
    v_cvt_pk_bf16_f32 v104, v104, v105
    v_and_b32 v105, 0xffff0000, v104
    v_lshlrev_b32 v104, 16, v104
    v_cvt_pk_bf16_f32 v106, v106, v107
    v_and_b32 v107, 0xffff0000, v106
    v_lshlrev_b32 v106, 16, v106
    v_cvt_pk_bf16_f32 v108, v108, v108
    v_lshlrev_b32 v108, 16, v108
    v_mul_f32 v100, v100, v121
    v_mul_f32 v101, v101, v121
    v_mul_f32 v102, v102, v121
    v_mul_f32 v103, v103, v121
    v_mul_f32 v104, v104, v121
    v_mul_f32 v105, v105, v121
    v_mul_f32 v106, v106, v121
    v_mul_f32 v107, v107, v121
    v_mul_f32 v108, v108, v121
    v_cvt_pk_bf16_f32 v100, v100, v101
    v_cvt_pk_bf16_f32 v101, v102, v103
    v_cvt_pk_bf16_f32 v102, v104, v105
    v_cvt_pk_bf16_f32 v103, v106, v107
    v_cvt_pk_bf16_f32 v108, v108, v108
    s_waitcnt lgkmcnt(0)
    s_barrier
    s_barrier
    s_mov_b32 s59, s57
    s_barrier
    s_cmp_ge_u32 s59, 162
    s_cbranch_scc1 L_ft_dk1_0
    s_cmp_ge_u32 s59, 81
    s_cselect_b32 s60, 81, 0
    s_sub_u32 s60, s59, s60
    s_lshl_b32 s60, s60, 6
    v_add_u32 v8, s60, v1
    v_mul_u32_u24 v9, 7282, v8
    v_lshrrev_b32 v9, 16, v9
    v_mul_u32_u24 v9, 63, v9
    v_add_u32 v8, v8, v9
    v_lshlrev_b32 v8, 7, v8
    s_mul_i32 s60, s4, 1152
    s_cmp_ge_u32 s59, 81
    s_cbranch_scc1 L_ft_uk1_0
    buffer_load_dword v12, v8, s[32:35], s60 offen
    s_branch L_ft_ek1_0
L_ft_uk1_0:
    buffer_load_dword v12, v8, s[36:39], s60 offen
    s_branch L_ft_ek1_0
L_ft_dk1_0:
    v_lshlrev_b32 v8, 7, v1
    s_mul_i32 s60, s4, 81
    s_add_u32 s60, s60, s59
    s_sub_u32 s60, s60, 162
    s_lshl_b32 s60, s60, 13
    s_cmp_ge_u32 s59, 243
    s_cselect_b32 s60, 5308416, s60
    buffer_load_dword v12, v8, s[40:43], s60 offen
L_ft_ek1_0:
    s_add_u32 s59, s59, 16
    s_cmp_ge_u32 s59, 162
    s_cbranch_scc1 L_ft_dk1_1
    s_cmp_ge_u32 s59, 81
    s_cselect_b32 s60, 81, 0
    s_sub_u32 s60, s59, s60
    s_lshl_b32 s60, s60, 6
    v_add_u32 v8, s60, v1
    v_mul_u32_u24 v9, 7282, v8
    v_lshrrev_b32 v9, 16, v9
    v_mul_u32_u24 v9, 63, v9
    v_add_u32 v8, v8, v9
    v_lshlrev_b32 v8, 7, v8
    s_mul_i32 s60, s4, 1152
    s_cmp_ge_u32 s59, 81
    s_cbranch_scc1 L_ft_uk1_1
    buffer_load_dword v12, v8, s[32:35], s60 offen
    s_branch L_ft_ek1_1
L_ft_uk1_1:
    buffer_load_dword v12, v8, s[36:39], s60 offen
    s_branch L_ft_ek1_1
L_ft_dk1_1:
    v_lshlrev_b32 v8, 7, v1
    s_mul_i32 s60, s4, 81
    s_add_u32 s60, s60, s59
    s_sub_u32 s60, s60, 162
    s_lshl_b32 s60, s60, 13
    s_cmp_ge_u32 s59, 243
    s_cselect_b32 s60, 5308416, s60
    buffer_load_dword v12, v8, s[40:43], s60 offen
L_ft_ek1_1:
    s_add_u32 s59, s59, 16
    s_cmp_ge_u32 s59, 162
    s_cbranch_scc1 L_ft_dk1_2
    s_cmp_ge_u32 s59, 81
    s_cselect_b32 s60, 81, 0
    s_sub_u32 s60, s59, s60
    s_lshl_b32 s60, s60, 6
    v_add_u32 v8, s60, v1
    v_mul_u32_u24 v9, 7282, v8
    v_lshrrev_b32 v9, 16, v9
    v_mul_u32_u24 v9, 63, v9
    v_add_u32 v8, v8, v9
    v_lshlrev_b32 v8, 7, v8
    s_mul_i32 s60, s4, 1152
    s_cmp_ge_u32 s59, 81
    s_cbranch_scc1 L_ft_uk1_2
    buffer_load_dword v12, v8, s[32:35], s60 offen
    s_branch L_ft_ek1_2
L_ft_uk1_2:
    buffer_load_dword v12, v8, s[36:39], s60 offen
    s_branch L_ft_ek1_2
L_ft_dk1_2:
    v_lshlrev_b32 v8, 7, v1
    s_mul_i32 s60, s4, 81
    s_add_u32 s60, s60, s59
    s_sub_u32 s60, s60, 162
    s_lshl_b32 s60, s60, 13
    s_cmp_ge_u32 s59, 243
    s_cselect_b32 s60, 5308416, s60
    buffer_load_dword v12, v8, s[40:43], s60 offen
L_ft_ek1_2:
    s_add_u32 s59, s59, 16
    s_barrier
    s_barrier
    s_barrier
    v_mov_b32 v8, 0x3f803f80
    v_mov_b32 v9, 0x3f803f80
    v_mov_b32 v10, 0x3f803f80
    v_mov_b32 v11, 0x3f803f80
    ds_read_b128 v[16:19], v5 offset:4096
    ds_read_b128 v[20:23], v5 offset:6144
    ds_read_b128 v[24:27], v5 offset:8192
    ds_read_b128 v[28:31], v5 offset:10240
    ds_read_b128 v[32:35], v5 offset:5120
    ds_read_b128 v[36:39], v5 offset:7168
    ds_read_b128 v[40:43], v5 offset:9216
    ds_read_b128 v[44:47], v5 offset:11264
    ds_read_b32 v48, v6
    s_waitcnt lgkmcnt(0)
    v_mfma_f32_16x16x32_bf16 v[56:59], v[8:11], v[16:19], 0
    v_mfma_f32_16x16x32_bf16 v[60:63], v[8:11], v[32:35], 0
    v_mfma_f32_16x16x32_bf16 v[56:59], v[8:11], v[20:23], v[56:59]
    v_mfma_f32_16x16x32_bf16 v[60:63], v[8:11], v[36:39], v[60:63]
    v_mfma_f32_16x16x32_bf16 v[56:59], v[8:11], v[24:27], v[56:59]
    v_mfma_f32_16x16x32_bf16 v[60:63], v[8:11], v[40:43], v[60:63]
    v_mfma_f32_16x16x32_bf16 v[56:59], v[8:11], v[28:31], v[56:59]
    v_mfma_f32_16x16x32_bf16 v[60:63], v[8:11], v[44:47], v[60:63]
    v_mov_b32 v49, s54
    v_mov_b32 v51, s54
    v_lshlrev_b32 v52, 4, v1
    s_lshl_b32 s56, s58, 9
    s_add_u32 s56, s56, 851968
    s_nop 2
    v_permlane16_swap_b32 v56, v60
    v_mov_b32 v50, v56
    s_mov_b32 exec_hi, 0
    buffer_store_dwordx4 v[48:51], v52, s[48:51], s56 offen sc1
    s_mov_b64 exec, -1
    s_branch L_K_ffn
L_end:
    s_endpgm
L_codeend:
.section .rodata,"a"
.p2align 6
.amdhsa_kernel recurrent_scan__compressed_kv_cla__glu_gated_geglu__decode_kernel
  .amdhsa_next_free_vgpr 168
  .amdhsa_next_free_sgpr 102
  .amdhsa_accum_offset 168
  .amdhsa_group_segment_fixed_size 0
  .amdhsa_kernarg_size 104
  .amdhsa_user_sgpr_count 2
  .amdhsa_user_sgpr_kernarg_segment_ptr 1
  .amdhsa_system_sgpr_workgroup_id_x 1
  .amdhsa_float_denorm_mode_32 3
  .amdhsa_float_denorm_mode_16_64 3
.end_amdhsa_kernel
```
